```python
import torch

def _softmax(x, axis=-1):
    return torch.softmax(x, dim=axis)
def _gelu(x):
    return torch.nn.functional.gelu(x, approximate="tanh")
def _silu(x):
    return torch.nn.functional.silu(x)
def _sigmoid(x):
    return torch.sigmoid(x)
def _layernorm(x, axis=-1, eps=1e-5):
    m = x.mean(dim=axis, keepdim=True)
    v = x.var(dim=axis, keepdim=True, unbiased=False)
    return (x - m) / torch.sqrt(v + eps)
def _scatter_add(tgt, idx, src, axis=0):
    return tgt.clone().index_add_(axis, idx, src)
def _segment_sum(src, seg, n):
    out = torch.zeros((n,) + src.shape[1:], dtype=src.dtype)
    return out.index_add_(0, seg, src)
def _pad(x, pw):
    flat = tuple(v for pair in reversed(pw) for v in pair)
    return torch.nn.functional.pad(x, flat)

kernel_name = 'parallel_sum__ssm_conv_s4d__mixer_channel_mlp__prompt'

def setup_inputs():

    _w = (lambda a: (lambda t: t.to(torch.bfloat16) if t.is_floating_point() else t)(torch.as_tensor(a)))
    def _A_setup():
        Bsz, L, D, N = 1, 2048, 640, 192
        return {
            "u": _w((lambda *s: torch.randn(*s, dtype=torch.bfloat16) * 0.05)(Bsz, L, D)),
            "log_A_real": _w((lambda *s: torch.randn(*s, dtype=torch.bfloat16) * 3.2)(D, N) * 0.5),
            "A_imag": _w((lambda *s: torch.randn(*s, dtype=torch.bfloat16) * 0.05)(D, N) * 3.14),
            "C_real": _w((lambda *s: torch.randn(*s, dtype=torch.bfloat16) * 0.1)(D, N) / N ** 0.5),
            "C_imag": _w((lambda *s: torch.randn(*s, dtype=torch.bfloat16) * 0.2)(D, N) / N ** 0.5),
            "log_dt": _w((lambda *s: torch.randn(*s, dtype=torch.bfloat16) * 0.05)(D) * 0.5 - 4.0),
            "D_skip": _w((lambda *s: torch.randn(*s, dtype=torch.bfloat16) * 0.05)(D)),
        }
    _A_in = _A_setup()

    def _B_setup():
        B, S, D, F = 1, 2048, 640, 1536
        return {
            "x": _w((lambda *s: torch.randn(*s, dtype=torch.bfloat16) * 0.05)(B, S, D)),
            "w1": _w((lambda *s: torch.randn(*s, dtype=torch.bfloat16) * 1.6)(D, F) * (D ** -0.5)),
            "b1": _w((lambda *s: torch.randn(*s, dtype=torch.bfloat16) * 0.8)(F)),
            "w2": _w((lambda *s: torch.randn(*s, dtype=torch.bfloat16) * 0.05)(F, D) * (F ** -0.5)),
            "b2": _w((lambda *s: torch.randn(*s, dtype=torch.bfloat16) * 0.05)(D)),
        }
    _B_in = _B_setup()

    return {
        "A_u": _A_in["u"],
        "A_log_A_real": _A_in["log_A_real"],
        "A_A_imag": _A_in["A_imag"],
        "A_C_real": _A_in["C_real"],
        "A_C_imag": _A_in["C_imag"],
        "A_log_dt": _A_in["log_dt"],
        "A_D_skip": _A_in["D_skip"],
        "B_x": _B_in["x"],
        "B_w1": _B_in["w1"],
        "B_b1": _B_in["b1"],
        "B_w2": _B_in["w2"],
        "B_b2": _B_in["b2"],
    }

def reference(A_u, A_log_A_real, A_A_imag, A_C_real, A_C_imag, A_log_dt, A_D_skip, B_x, B_w1, B_b1, B_w2, B_b2):
    def _A_ref(u, log_A_real, A_imag, C_real, C_imag, log_dt, D_skip):
        L = u.shape[1]
        dt = torch.exp(log_dt)
        A = -torch.exp(log_A_real) + 1j * A_imag
        C = (C_real + 1j * C_imag) * dt[:, None]
        pos = (lambda x, dt: x.to(dt))(torch.arange(L), log_dt.dtype)
        P = torch.exp((A * dt[:, None])[:, :, None] * pos[None, None, :])
        K = 2.0 * torch.einsum("dn,dnl->dl", C, P).real
        L2 = 2 * L
        u_t = (lambda x, *d: x.permute(*d))(u, 0, 2, 1)
        Kf = (lambda x, *a, **k: torch.fft.rfft(x.float(), *a, **k))(K, L2)
        Uf = (lambda x, *a, **k: torch.fft.rfft(x.float(), *a, **k))(u_t, L2)
        y = (lambda x, *a, **k: torch.fft.irfft(x, *a, **k).to(torch.bfloat16))(Uf * Kf[None, :, :], L2)[:, :, :L]
        y = (lambda x, *d: x.permute(*d))(y, 0, 2, 1)
        return y + u * D_skip[None, None, :]

    def _B_ref(x, w1, b1, w2, b2):
        y = _layernorm(x, axis=-1)
        h = _gelu(torch.einsum("bsd,df->bsf", y, w1) + b1)
        return torch.einsum("bsf,fd->bsd", h, w2) + b2

    x = A_u
    xn = _layernorm(x, axis=-1)
    return x + _A_ref(xn, A_log_A_real, A_A_imag, A_C_real, A_C_imag, A_log_dt, A_D_skip) + _B_ref(xn, B_w1, B_b1, B_w2, B_b2)
```

```asm
; @launch grid=(256,1,1) block=(512,1,1) lds=163840
.amdgcn_target "amdgcn-amd-amdhsa--gfx950"
.text
.globl parallel_sum__ssm_conv_s4d__mixer_channel_mlp__prompt_kernel
.p2align 8
.type parallel_sum__ssm_conv_s4d__mixer_channel_mlp__prompt_kernel,@function
parallel_sum__ssm_conv_s4d__mixer_channel_mlp__prompt_kernel:
    s_cmp_ge_u32 s2, 256
    s_cbranch_scc1 L_END
    s_load_dwordx16 s[4:19], s[0:1], 0
    s_load_dwordx8 s[20:27], s[0:1], 64
    s_load_dwordx4 s[28:31], s[0:1], 96
    s_load_dwordx2 s[32:33], s[0:1], 112
    v_lshrrev_b32 v2, 6, v0
    v_and_b32 v1, 63, v0
    s_and_b32 s35, s2, 7
    v_readfirstlane_b32 s34, v2
    s_lshr_b32 s36, s2, 3
    s_xor_b32 s34, s34, 4
    s_cmp_lt_u32 s36, 24
    s_cselect_b32 s76, 4, 0
    s_cmp_lt_u32 s34, s76
    s_cbranch_scc1 L_GE
    s_setprio 3
    s_cmp_ge_u32 s36, 24
    s_cselect_b32 s37, 1, 0
    s_cselect_b32 s76, 3, 1
    s_cselect_b32 s77, -48, 0
    s_lshr_b32 s78, s34, 1
    s_and_b32 s78, s78, s76
    s_add_u32 s76, s37, 1
    s_lshl_b32 s76, s36, s76
    s_mul_i32 s61, s35, 80
    s_add_u32 s61, s61, s76
    s_add_u32 s61, s61, s77
    s_add_u32 s61, s61, s78
    s_mul_i32 s76, s61, 384
    v_and_b32 v7, 31, v1
    v_mul_u32_u24 v2, 12, v7
    v_add_u32 v2, s76, v2
    s_lshl_b32 s66, s61, 1
    s_and_b32 s66, s66, 0xfffc
    s_lshl_b32 s76, s37, 3
    s_add_u32 s76, s76, s34
    s_cmp_eq_u32 s76, 12
    s_cbranch_scc0 CP1
    s_getpc_b64 s[68:69]
CP1pc:
    s_sub_u32 s68, s68, CP1pc-parallel_sum__ssm_conv_s4d__mixer_channel_mlp__prompt_kernel
    s_subb_u32 s69, s69, 0
    s_sub_u32 s76, s36, 24
    s_mul_i32 s76, s76, 5120
    v_min_u32 v7, 39, v1
    v_lshl_add_u32 v7, v7, 7, s76
    v_min_u32 v7, L_END-parallel_sum__ssm_conv_s4d__mixer_channel_mlp__prompt_kernel, v7
    global_load_dword v255, v7, s[68:69]
CP1:
    s_waitcnt lgkmcnt(0)
    s_nop 0
    global_load_dwordx3 v[16:18], v2, s[6:7]
    global_load_dwordx3 v[20:22], v2, s[8:9]
    global_load_dwordx3 v[24:26], v2, s[10:11]
    global_load_dwordx3 v[28:30], v2, s[12:13]
    s_load_dword s72, s[14:15], s66
    s_load_dword s73, s[16:17], s66
    s_mov_b32 s42, 2621440
    s_mov_b32 s43, 0x20000
    s_mov_b32 s46, 1966080
    s_mov_b32 s47, 0x20000
    s_mov_b32 s50, 1966080
    s_mov_b32 s51, 0x20000
    s_mov_b32 s54, 16777216
    s_mov_b32 s55, 0x20000
    s_mov_b32 s58, 2621440
    s_mov_b32 s59, 0x20000
    s_mov_b32 s40, s4
    s_mov_b32 s41, s5
    s_mov_b32 s44, s20
    s_mov_b32 s45, s21
    s_mov_b32 s48, s24
    s_mov_b32 s49, s25
    s_mov_b32 s52, s32
    s_mov_b32 s53, s33
    s_mov_b32 s56, s28
    s_mov_b32 s57, s29
    s_mov_b32 s76, 13680640
    s_load_dword s21, s[32:33], s76
    s_and_b32 s60, s34, 1
    s_mov_b32 s38, 49152
    s_mov_b32 s39, 82432
    s_cmp_eq_u32 s37, 0
    s_cselect_b32 s38, 131072, s38
    s_cselect_b32 s39, 147712, s39
    s_mul_i32 s76, s78, 8320
    s_add_u32 s38, s38, s76
    s_lshr_b32 s76, s78, 1
    s_mul_i32 s76, s76, 9216
    s_and_b32 s77, s78, 1
    s_lshl_b32 s77, s77, 9
    s_add_u32 s39, s39, s76
    s_add_u32 s39, s39, s77
    s_lshl_b32 s62, s35, 3
    s_add_u32 s62, s62, s36
    s_sub_u32 s62, s62, 24
    s_lshl_b32 s63, s62, 5
    s_lshl_b32 s76, s34, 2
    s_add_u32 s63, s63, s76
    s_mul_i32 s64, s63, 1280
    v_mov_b32 v14, 0
    v_mov_b32 v15, 0
    v_lshrrev_b32 v4, 4, v1
    v_and_b32 v5, 15, v1
    v_mul_u32_u24 v6, 1280, v4
    v_lshl_add_u32 v248, v5, 4, v6
    s_cmp_lt_u32 s34, 4
    s_cselect_b32 s19, -1, 0
    s_cmp_eq_u32 s37, 0
    s_cselect_b32 s19, 3, s19
    s_cmp_eq_u32 s37, 0
    s_cbranch_scc1 NX2
    buffer_load_dwordx4 v[228:231], v248, s[40:43], s64 offen offset:0
    buffer_load_dwordx4 v[232:235], v248, s[40:43], s64 offen offset:256
    buffer_load_dwordx4 v[236:239], v248, s[40:43], s64 offen offset:512
    buffer_load_dwordx4 v[240:243], v248, s[40:43], s64 offen offset:768
    buffer_load_dwordx4 v[244:247], v248, s[40:43], s64 offen offset:1024
NX2:
    s_sub_u32 s76, s36, 24
    s_lshl_b32 s76, s76, 3
    s_add_u32 s76, s76, s34
    s_mul_i32 s76, s76, 64
    s_mul_i32 s77, s35, 1920
    s_add_u32 s76, s76, s77
    s_add_u32 s76, s76, 0
    v_min_u32 v249, 63, v1
    v_add_lshl_u32 v249, v249, s76, 7
    s_xor_b32 s76, s60, 1
    s_mul_i32 s76, s76, 4160
    s_add_u32 s76, s76, s38
    v_lshl_add_u32 v202, v1, 4, s76
    s_mul_i32 s76, s60, 4160
    s_add_u32 s76, s76, s38
    v_lshl_add_u32 v203, v1, 4, s76
    v_mov_b32 v205, s76
    s_add_u32 s76, s76, 1008
    v_lshlrev_b32 v5, 4, v1
    v_sub_u32 v204, s76, v5
    v_mov_b32 v8, 0
    v_mov_b32 v9, 0
    v_mov_b32 v10, 0
    v_mov_b32_e64 v11, 0
    v_lshl_add_u32 v6, v1, 3, s39
    ds_write_b64 v6, v[8:9]
    s_mov_b64 exec, 7
    ds_write_b128 v203, v[8:11] offset:4096
    s_mov_b64 exec, -1
    v_lshrrev_b32_e64 v3, 5, v1
    v_cmp_eq_u32 s[74:75], 1, v3
    v_bfe_u32 v4, v1, 4, 1
    v_and_b32 v5, 15, v1
    v_cmp_eq_u32 vcc, v3, v4
    s_nop 1
    v_cndmask_b32 v5, 64, v5, vcc
    v_and_b32_e64 v6, 3, v1
    v_bfe_u32 v7, v1, 3, 2
    v_lshl_add_u32 v6, v7, 2, v6
    v_add_u32 v7, 1, v6
    v_and_b32 v7, 12, v7
    v_and_b32 v8, 9, v6
    v_cmp_eq_u32 vcc, 1, v8
    s_nop 0
    s_and_b64 vcc, vcc, s[74:75]
    v_cndmask_b32 v6, v6, v7, vcc
    v_bfe_u32 v4, v1, 2, 1
    v_cmp_eq_u32 vcc, v3, v4
    s_nop 1
    v_cndmask_b32 v6, 64, v6, vcc
    v_mov_b32 v9, 0x3f80
    v_and_b32 v7, 1, v5
    v_lshlrev_b32 v7, 4, v7
    v_lshlrev_b32 v7, v7, v9
    v_lshrrev_b32 v8, 1, v5
    v_cmp_eq_u32 vcc, 0, v8
    v_cmp_eq_u32 s[76:77], 1, v8
    v_nop
    v_cndmask_b32 v32, 0, v7, vcc
    v_cndmask_b32 v33, 0, v7, s[76:77]
    v_cmp_eq_u32 vcc, 2, v8
    v_cmp_eq_u32 s[76:77], 3, v8
    v_nop
    v_cndmask_b32 v34, 0, v7, vcc
    v_cndmask_b32 v35, 0, v7, s[76:77]
    v_cmp_eq_u32 vcc, 4, v8
    v_cmp_eq_u32 s[76:77], 5, v8
    v_nop
    v_cndmask_b32 v36, 0, v7, vcc
    v_cndmask_b32 v37, 0, v7, s[76:77]
    v_cmp_eq_u32 vcc, 6, v8
    v_cmp_eq_u32 s[76:77], 7, v8
    v_nop
    v_cndmask_b32 v38, 0, v7, vcc
    v_cndmask_b32 v39, 0, v7, s[76:77]
    v_and_b32 v7, 1, v6
    v_lshlrev_b32 v7, 4, v7
    v_lshlrev_b32 v7, v7, v9
    v_lshrrev_b32 v8, 1, v6
    v_cmp_eq_u32 vcc, 0, v8
    v_cmp_eq_u32 s[76:77], 1, v8
    v_nop
    v_cndmask_b32 v40, 0, v7, vcc
    v_cndmask_b32 v41, 0, v7, s[76:77]
    v_cmp_eq_u32 vcc, 2, v8
    v_cmp_eq_u32 s[76:77], 3, v8
    v_nop
    v_cndmask_b32 v42, 0, v7, vcc
    v_cndmask_b32 v43, 0, v7, s[76:77]
    v_cmp_eq_u32 vcc, 4, v8
    v_cmp_eq_u32 s[76:77], 5, v8
    v_nop
    v_cndmask_b32 v44, 0, v7, vcc
    v_cndmask_b32 v45, 0, v7, s[76:77]
    v_cmp_eq_u32 vcc, 6, v8
    v_cmp_eq_u32 s[76:77], 7, v8
    v_nop
    v_cndmask_b32 v46, 0, v7, vcc
    v_cndmask_b32 v47, 0, v7, s[76:77]
    s_and_b32 s3, s34, 3
    s_mov_b64 exec, 0
    s_cmp_eq_u32 s3, 0
    s_cbranch_scc1 PADS0
    s_cmp_eq_u32 s3, 1
    s_cbranch_scc1 PADS1
    s_cmp_eq_u32 s3, 2
    s_cbranch_scc1 PADS2
    s_cmp_eq_u32 s3, 3
    s_cbranch_scc1 PADS3
WR3:
    s_mov_b64 exec, -1
    v_mov_b32 v4, 0x41000000
    v_mov_b32 v5, 0x43000000
    v_cndmask_b32 v50, v4, v5, s[74:75]
    v_mov_b32 v5, 0x43800000
    v_cndmask_b32 v51, 1.0, v5, s[74:75]
    s_and_b32 s76, s61, 1
    s_xor_b32 s76, s76, 1
    s_lshl_b32 s76, s76, 4
    s_mul_i32 s77, s60, 0x02020000
    s_add_u32 s77, s77, 0x01000c0c
    s_waitcnt lgkmcnt(0)
    s_mul_i32 s21, s21, 0x9e3779b1
    s_add_u32 s21, s21, 0x7f4a7c15
    s_lshl_b32 s72, s72, s76
    s_and_b32 s72, s72, 0xffff0000
    s_lshl_b32 s73, s73, s76
    s_and_b32 s73, s73, 0xffff0000
    v_mov_b32 v48, s72
    v_mul_f32 v48, 0x3fb8aa3b, v48
    v_exp_f32 v48, v48
    v_mov_b32 v31, s73
    v_cvt_pk_bf16_f32 v48, v48, v48
    v_lshlrev_b32 v48, 16, v48
    v_add_f32 v49, v48, v48
    v_cmp_eq_u32 vcc, 0, v1
    s_nop 1
    v_cndmask_b32 v31, 0, v31, vcc
    s_branch L_K
.p2align 12
L_K:
PADS0:
    s_cbranch_execz WR3
    s_setprio 2
    s_cmp_eq_u32 s37, 0
    s_cbranch_scc1 NX5
    s_waitcnt vmcnt(5)
    s_branch NG4
NX5:
    s_waitcnt vmcnt(0)
NG4:
    s_nop 0
    v_perm_b32 v16, v16, v16, s77
    v_perm_b32 v17, v17, v17, s77
    v_perm_b32 v18, v18, v18, s77
    v_perm_b32 v20, v20, v20, s77
    v_perm_b32 v21, v21, v21, s77
    v_perm_b32 v22, v22, v22, s77
    v_perm_b32 v24, v24, v24, s77
    v_perm_b32 v25, v25, v25, s77
    v_perm_b32 v26, v26, v26, s77
    v_perm_b32 v28, v28, v28, s77
    v_perm_b32 v29, v29, v29, s77
    v_perm_b32 v30, v30, v30, s77
    s_cmp_eq_u32 s19, -1
    s_cbranch_scc1 L_LN
L_LNRm:
    v_mul_f32 v4, 0x3fb8aa3b, v16
    v_exp_f32 v4, v4
    v_mul_f32 v5, v20, v48
    v_cvt_pk_bf16_f32 v4, v4, v4
    v_mul_f32 v5, 0x3e22f983, v5
    v_lshlrev_b32 v4, 16, v4
    v_mul_f32 v7, v5, v50
    v_mul_f32 v4, v4, v48
    v_mul_f32 v9, v5, v51
    v_mul_f32 v4, 0xbfb8aa3b, v4
    v_rndne_f32 v10, v7
    v_rndne_f32 v11, v9
    v_mul_f32 v6, v4, v50
    v_mul_f32 v8, v4, v51
    v_sub_f32 v7, v7, v10
    v_sub_f32 v9, v11, v9
    v_exp_f32 v6, v6
    v_exp_f32 v8, v8
    v_sin_f32 v10, v7
    v_cos_f32 v11, v7
    v_sin_f32 v12, v9
    v_cos_f32 v13, v9
    v_mul_f32 v197, v10, v6
    v_mul_f32 v196, v11, v6
    v_mul_f32 v199, v12, v8
    v_mul_f32 v198, v13, v8
    v_mul_f32 v209, v10, v6
    v_mul_f32 v208, v11, v6
    v_mul_f32 v211, v12, v8
    v_mul_f32 v210, v13, v8
    v_mul_f32 v4, v24, v49
    v_mul_f32 v5, v28, v49
    v_permlane32_swap_b32 v197, v209
    v_permlane32_swap_b32 v196, v208
    v_permlane32_swap_b32 v199, v211
    v_permlane32_swap_b32 v198, v210
    v_cndmask_b32 v212, 1.0, v208, s[74:75]
    v_cndmask_b32 v213, 0, v209, s[74:75]
    v_cndmask_b32 v6, 1.0, v210, s[74:75]
    v_cndmask_b32 v7, 0, v211, s[74:75]
    v_mul_f32 v200, v210, v210
    v_add_f32 v8, v210, v210
    v_fma_f32 v200, -v211, v211, v200
    v_mul_f32 v201, v8, v211
    v_mul_f32 v216, v4, v6
    v_mul_f32 v217, v4, v7
    v_fmac_f32_e64 v216, v5, v7
    v_fma_f32 v217, -v5, v6, v217
    v_pk_mul_f32 v[214:215], v[212:213], v[196:197] op_sel:[1,1] op_sel_hi:[0,1] neg_lo:[0,1]
    v_pk_mul_f32 v[222:223], v[216:217], v[198:199] op_sel:[1,1] op_sel_hi:[0,1] neg_lo:[0,1]
    v_pk_fma_f32 v[214:215], v[212:213], v[196:197], v[214:215] op_sel_hi:[1,0,1]
    v_pk_fma_f32 v[222:223], v[216:217], v[198:199], v[222:223] op_sel_hi:[1,0,1]
    v_cvt_pk_bf16_f32 v68, v212, v214
    v_cvt_pk_bf16_f32 v84, v216, v222
    v_cvt_pk_bf16_f32 v76, v213, v215
    v_cvt_pk_bf16_f32 v92, v217, v223
    v_pk_mul_f32 v[212:213], v[214:215], v[196:197] op_sel:[1,1] op_sel_hi:[0,1] neg_lo:[0,1]
    v_pk_mul_f32 v[224:225], v[222:223], v[198:199] op_sel:[1,1] op_sel_hi:[0,1] neg_lo:[0,1]
    v_pk_fma_f32 v[212:213], v[214:215], v[196:197], v[212:213] op_sel_hi:[1,0,1]
    v_pk_fma_f32 v[224:225], v[222:223], v[198:199], v[224:225] op_sel_hi:[1,0,1]
    v_pk_mul_f32 v[214:215], v[212:213], v[196:197] op_sel:[1,1] op_sel_hi:[0,1] neg_lo:[0,1]
    v_pk_mul_f32 v[222:223], v[224:225], v[198:199] op_sel:[1,1] op_sel_hi:[0,1] neg_lo:[0,1]
    v_pk_fma_f32 v[214:215], v[212:213], v[196:197], v[214:215] op_sel_hi:[1,0,1]
    v_pk_fma_f32 v[222:223], v[224:225], v[198:199], v[222:223] op_sel_hi:[1,0,1]
    v_cvt_pk_bf16_f32 v69, v212, v214
    v_cvt_pk_bf16_f32 v85, v224, v222
    v_cvt_pk_bf16_f32 v77, v213, v215
    v_cvt_pk_bf16_f32 v93, v225, v223
    v_pk_mul_f32 v[212:213], v[214:215], v[196:197] op_sel:[1,1] op_sel_hi:[0,1] neg_lo:[0,1]
    v_pk_mul_f32 v[218:219], v[222:223], v[198:199] op_sel:[1,1] op_sel_hi:[0,1] neg_lo:[0,1]
    v_pk_fma_f32 v[212:213], v[214:215], v[196:197], v[212:213] op_sel_hi:[1,0,1]
    v_pk_fma_f32 v[218:219], v[222:223], v[198:199], v[218:219] op_sel_hi:[1,0,1]
    v_pk_mul_f32 v[214:215], v[212:213], v[196:197] op_sel:[1,1] op_sel_hi:[0,1] neg_lo:[0,1]
    v_pk_mul_f32 v[222:223], v[218:219], v[198:199] op_sel:[1,1] op_sel_hi:[0,1] neg_lo:[0,1]
    v_pk_fma_f32 v[214:215], v[212:213], v[196:197], v[214:215] op_sel_hi:[1,0,1]
    v_pk_fma_f32 v[222:223], v[218:219], v[198:199], v[222:223] op_sel_hi:[1,0,1]
    v_cvt_pk_bf16_f32 v70, v212, v214
    v_cvt_pk_bf16_f32 v86, v218, v222
    v_cvt_pk_bf16_f32 v78, v213, v215
    v_cvt_pk_bf16_f32 v94, v219, v223
    v_pk_mul_f32 v[212:213], v[214:215], v[196:197] op_sel:[1,1] op_sel_hi:[0,1] neg_lo:[0,1]
    v_pk_mul_f32 v[224:225], v[222:223], v[198:199] op_sel:[1,1] op_sel_hi:[0,1] neg_lo:[0,1]
    v_pk_fma_f32 v[212:213], v[214:215], v[196:197], v[212:213] op_sel_hi:[1,0,1]
    v_pk_fma_f32 v[224:225], v[222:223], v[198:199], v[224:225] op_sel_hi:[1,0,1]
    v_pk_mul_f32 v[214:215], v[212:213], v[196:197] op_sel:[1,1] op_sel_hi:[0,1] neg_lo:[0,1]
    v_pk_mul_f32 v[222:223], v[224:225], v[198:199] op_sel:[1,1] op_sel_hi:[0,1] neg_lo:[0,1]
    v_pk_fma_f32 v[214:215], v[212:213], v[196:197], v[214:215] op_sel_hi:[1,0,1]
    v_pk_fma_f32 v[222:223], v[224:225], v[198:199], v[222:223] op_sel_hi:[1,0,1]
    v_cvt_pk_bf16_f32 v71, v212, v214
    v_cvt_pk_bf16_f32 v87, v224, v222
    v_cvt_pk_bf16_f32 v79, v213, v215
    v_cvt_pk_bf16_f32 v95, v225, v223
    v_pk_mul_f32 v[212:213], v[214:215], v[196:197] op_sel:[1,1] op_sel_hi:[0,1] neg_lo:[0,1]
    v_pk_mul_f32 v[220:221], v[222:223], v[198:199] op_sel:[1,1] op_sel_hi:[0,1] neg_lo:[0,1]
    v_pk_fma_f32 v[212:213], v[214:215], v[196:197], v[212:213] op_sel_hi:[1,0,1]
    v_pk_fma_f32 v[220:221], v[222:223], v[198:199], v[220:221] op_sel_hi:[1,0,1]
    v_pk_mul_f32 v[214:215], v[212:213], v[196:197] op_sel:[1,1] op_sel_hi:[0,1] neg_lo:[0,1]
    v_pk_mul_f32 v[222:223], v[216:217], v[200:201] op_sel:[1,1] op_sel_hi:[0,1] neg_lo:[0,1]
    v_pk_fma_f32 v[214:215], v[212:213], v[196:197], v[214:215] op_sel_hi:[1,0,1]
    v_pk_fma_f32 v[222:223], v[216:217], v[200:201], v[222:223] op_sel_hi:[1,0,1]
    v_cvt_pk_bf16_f32 v72, v212, v214
    v_cvt_pk_bf16_f32 v88, v220, v222
    v_cvt_pk_bf16_f32 v80, v213, v215
    v_cvt_pk_bf16_f32 v96, v221, v223
    v_pk_mul_f32 v[212:213], v[214:215], v[196:197] op_sel:[1,1] op_sel_hi:[0,1] neg_lo:[0,1]
    v_pk_mul_f32 v[224:225], v[218:219], v[200:201] op_sel:[1,1] op_sel_hi:[0,1] neg_lo:[0,1]
    v_pk_fma_f32 v[212:213], v[214:215], v[196:197], v[212:213] op_sel_hi:[1,0,1]
    v_pk_fma_f32 v[224:225], v[218:219], v[200:201], v[224:225] op_sel_hi:[1,0,1]
    v_pk_mul_f32 v[214:215], v[212:213], v[196:197] op_sel:[1,1] op_sel_hi:[0,1] neg_lo:[0,1]
    v_pk_mul_f32 v[216:217], v[220:221], v[200:201] op_sel:[1,1] op_sel_hi:[0,1] neg_lo:[0,1]
    v_pk_fma_f32 v[214:215], v[212:213], v[196:197], v[214:215] op_sel_hi:[1,0,1]
    v_pk_fma_f32 v[216:217], v[220:221], v[200:201], v[216:217] op_sel_hi:[1,0,1]
    v_cvt_pk_bf16_f32 v73, v212, v214
    v_cvt_pk_bf16_f32 v89, v224, v216
    v_cvt_pk_bf16_f32 v81, v213, v215
    v_cvt_pk_bf16_f32 v97, v225, v217
    v_pk_mul_f32 v[212:213], v[214:215], v[196:197] op_sel:[1,1] op_sel_hi:[0,1] neg_lo:[0,1]
    v_pk_mul_f32 v[218:219], v[222:223], v[200:201] op_sel:[1,1] op_sel_hi:[0,1] neg_lo:[0,1]
    v_pk_fma_f32 v[212:213], v[214:215], v[196:197], v[212:213] op_sel_hi:[1,0,1]
    v_pk_fma_f32 v[218:219], v[222:223], v[200:201], v[218:219] op_sel_hi:[1,0,1]
    v_pk_mul_f32 v[214:215], v[212:213], v[196:197] op_sel:[1,1] op_sel_hi:[0,1] neg_lo:[0,1]
    v_pk_mul_f32 v[220:221], v[216:217], v[200:201] op_sel:[1,1] op_sel_hi:[0,1] neg_lo:[0,1]
    v_pk_fma_f32 v[214:215], v[212:213], v[196:197], v[214:215] op_sel_hi:[1,0,1]
    v_pk_fma_f32 v[220:221], v[216:217], v[200:201], v[220:221] op_sel_hi:[1,0,1]
    v_cvt_pk_bf16_f32 v74, v212, v214
    v_cvt_pk_bf16_f32 v90, v218, v220
    v_cvt_pk_bf16_f32 v82, v213, v215
    v_cvt_pk_bf16_f32 v98, v219, v221
    v_pk_mul_f32 v[212:213], v[214:215], v[196:197] op_sel:[1,1] op_sel_hi:[0,1] neg_lo:[0,1]
    v_pk_mul_f32 v[222:223], v[218:219], v[200:201] op_sel:[1,1] op_sel_hi:[0,1] neg_lo:[0,1]
    v_pk_fma_f32 v[212:213], v[214:215], v[196:197], v[212:213] op_sel_hi:[1,0,1]
    v_pk_fma_f32 v[222:223], v[218:219], v[200:201], v[222:223] op_sel_hi:[1,0,1]
    v_pk_mul_f32 v[214:215], v[212:213], v[196:197] op_sel:[1,1] op_sel_hi:[0,1] neg_lo:[0,1]
    v_pk_mul_f32 v[224:225], v[220:221], v[200:201] op_sel:[1,1] op_sel_hi:[0,1] neg_lo:[0,1]
    v_pk_fma_f32 v[214:215], v[212:213], v[196:197], v[214:215] op_sel_hi:[1,0,1]
    v_pk_fma_f32 v[224:225], v[220:221], v[200:201], v[224:225] op_sel_hi:[1,0,1]
    v_cvt_pk_bf16_f32 v75, v212, v214
    v_cvt_pk_bf16_f32 v91, v222, v224
    v_cvt_pk_bf16_f32 v83, v213, v215
    v_cvt_pk_bf16_f32 v99, v223, v225
    s_cmp_eq_u32 s19, 0
    s_cbranch_scc1 L_LN
L_LNR0:
    v_mfma_f32_32x32x16_bf16 v[100:115], v[68:71], v[32:35], 0
    v_mul_f32 v4, 0x3fb8aa3b, v17
    v_exp_f32 v4, v4
    v_mul_f32 v5, v21, v48
    v_cvt_pk_bf16_f32 v4, v4, v4
    v_mul_f32 v5, 0x3e22f983, v5
    v_lshlrev_b32 v4, 16, v4
    v_mfma_f32_32x32x16_bf16 v[100:115], v[72:75], v[36:39], v[100:115]
    v_mul_f32 v7, v5, v50
    v_mul_f32 v4, v4, v48
    v_mul_f32 v9, v5, v51
    v_mul_f32 v4, 0xbfb8aa3b, v4
    v_rndne_f32 v10, v7
    v_rndne_f32 v11, v9
    v_mfma_f32_32x32x16_bf16 v[132:147], v[84:87], v[40:43], 0
    v_mul_f32 v6, v4, v50
    v_mul_f32 v8, v4, v51
    v_sub_f32 v7, v7, v10
    v_sub_f32 v9, v11, v9
    v_exp_f32 v6, v6
    v_exp_f32 v8, v8
    v_mfma_f32_32x32x16_bf16 v[132:147], v[88:91], v[44:47], v[132:147]
    v_sin_f32 v10, v7
    v_cos_f32 v11, v7
    v_sin_f32 v12, v9
    s_cmp_eq_u32 s37, 0
    s_cbranch_scc1 NH6
    s_waitcnt vmcnt(0)
    s_barrier
    s_cmp_eq_u32 s34, 0
    s_cbranch_scc0 NH6
    s_lshl_b32 s76, s62, 7
    s_add_u32 s76, s76, 13664256
    v_mov_b32 v250, s21
    v_mov_b32 v251, s21
    v_mov_b32 v252, s21
    v_mov_b32 v253, s21
    v_lshlrev_b32 v254, 4, v1
    s_mov_b64 exec, 0xff
    buffer_store_dwordx4 v[250:253], v254, s[52:55], s76 offen sc1
    s_mov_b64 exec, -1
NH6:
    v_cos_f32 v13, v9
    v_mul_f32 v197, v10, v6
    v_mul_f32 v196, v11, v6
    v_mfma_f32_32x32x16_bf16 v[116:131], v[76:79], v[32:35], 0
    v_mfma_f32_32x32x16_bf16 v[116:131], v[80:83], v[36:39], v[116:131]
    v_cvt_pk_bf16_f32 v164, v100, v101
    v_cvt_pk_bf16_f32 v165, v102, v103
    s_cmp_eq_u32 s37, 0
    s_cbranch_scc1 TC7
    v_add_u32 v254, -1966080, v249
    v_min_u32_e64 v254, v254, v249
    buffer_load_dword v255, v254, s[48:51], 0 offen
    v_add_u32 v249, 524288, v249
TC7:
    v_cvt_pk_bf16_f32 v166, v104, v105
    v_cvt_pk_bf16_f32 v167, v106, v107
    v_cvt_pk_bf16_f32 v168, v108, v109
    v_cvt_pk_bf16_f32 v169, v110, v111
    v_mfma_f32_32x32x16_bf16 v[148:163], v[92:95], v[40:43], 0
    v_cvt_pk_bf16_f32 v170, v112, v113
    v_cvt_pk_bf16_f32 v171, v114, v115
    v_cvt_pk_bf16_f32 v180, v132, v133
    v_cvt_pk_bf16_f32 v181, v134, v135
    v_cvt_pk_bf16_f32 v182, v136, v137
    v_cvt_pk_bf16_f32 v183, v138, v139
    v_mfma_f32_32x32x16_bf16 v[148:163], v[96:99], v[44:47], v[148:163]
    v_cvt_pk_bf16_f32 v184, v140, v141
    v_cvt_pk_bf16_f32 v185, v142, v143
    v_cvt_pk_bf16_f32 v186, v144, v145
    v_cvt_pk_bf16_f32 v187, v146, v147
    v_mfma_f32_32x32x16_bf16 v[52:67], v[180:183], v[164:167], 0
    v_mul_f32 v199, v12, v8
    v_mul_f32 v198, v13, v8
    v_mul_f32 v209, v10, v6
    v_mul_f32 v208, v11, v6
    v_mul_f32 v211, v12, v8
    v_mul_f32 v210, v13, v8
    v_mfma_f32_32x32x16_bf16 v[52:67], v[184:187], v[168:171], v[52:67]
    v_cvt_pk_bf16_f32 v172, v116, v117
    v_cvt_pk_bf16_f32 v173, v118, v119
    v_cvt_pk_bf16_f32 v174, v120, v121
    v_cvt_pk_bf16_f32 v175, v122, v123
    v_cvt_pk_bf16_f32 v176, v124, v125
    v_cvt_pk_bf16_f32 v177, v126, v127
    v_cvt_pk_bf16_f32 v178, v128, v129
    v_cvt_pk_bf16_f32 v179, v130, v131
    v_cvt_pk_bf16_f32 v188, v148, v149
    v_cvt_pk_bf16_f32 v189, v150, v151
    v_cvt_pk_bf16_f32 v190, v152, v153
    v_cvt_pk_bf16_f32 v191, v154, v155
    v_cvt_pk_bf16_f32 v192, v156, v157
    v_cvt_pk_bf16_f32 v193, v158, v159
    v_cvt_pk_bf16_f32 v194, v160, v161
    v_cvt_pk_bf16_f32 v195, v162, v163
    v_mfma_f32_32x32x16_bf16 v[52:67], v[188:191], v[172:175], v[52:67]
    v_mul_f32 v4, v25, v49
    v_mul_f32 v5, v29, v49
    v_permlane32_swap_b32 v197, v209
    v_permlane32_swap_b32 v196, v208
    v_permlane32_swap_b32 v199, v211
    v_permlane32_swap_b32 v198, v210
    v_mfma_f32_32x32x16_bf16 v[52:67], v[192:195], v[176:179], v[52:67]
    v_cndmask_b32 v212, 1.0, v208, s[74:75]
    v_cndmask_b32 v213, 0, v209, s[74:75]
    v_cndmask_b32 v6, 1.0, v210, s[74:75]
    v_cndmask_b32 v7, 0, v211, s[74:75]
    v_mul_f32 v200, v210, v210
    v_add_f32 v8, v210, v210
    v_fma_f32 v200, -v211, v211, v200
    v_mul_f32 v201, v8, v211
    v_mul_f32 v216, v4, v6
    v_mul_f32 v217, v4, v7
    v_fmac_f32 v216, v5, v7
    v_fma_f32 v217, -v5, v6, v217
    v_pk_mul_f32 v[214:215], v[212:213], v[196:197] op_sel:[1,1] op_sel_hi:[0,1] neg_lo:[0,1]
    v_pk_mul_f32 v[222:223], v[216:217], v[198:199] op_sel:[1,1] op_sel_hi:[0,1] neg_lo:[0,1]
    v_pk_fma_f32 v[214:215], v[212:213], v[196:197], v[214:215] op_sel_hi:[1,0,1]
    v_pk_fma_f32 v[222:223], v[216:217], v[198:199], v[222:223] op_sel_hi:[1,0,1]
    v_cvt_pk_bf16_f32 v68, v212, v214
    v_cvt_pk_bf16_f32 v84, v216, v222
    v_cvt_pk_bf16_f32 v76, v213, v215
    v_cvt_pk_bf16_f32 v92, v217, v223
    v_pk_mul_f32 v[212:213], v[214:215], v[196:197] op_sel:[1,1] op_sel_hi:[0,1] neg_lo:[0,1]
    v_pk_mul_f32 v[224:225], v[222:223], v[198:199] op_sel:[1,1] op_sel_hi:[0,1] neg_lo:[0,1]
    v_pk_fma_f32 v[212:213], v[214:215], v[196:197], v[212:213] op_sel_hi:[1,0,1]
    v_pk_fma_f32 v[224:225], v[222:223], v[198:199], v[224:225] op_sel_hi:[1,0,1]
    v_pk_mul_f32 v[214:215], v[212:213], v[196:197] op_sel:[1,1] op_sel_hi:[0,1] neg_lo:[0,1]
    v_pk_mul_f32 v[222:223], v[224:225], v[198:199] op_sel:[1,1] op_sel_hi:[0,1] neg_lo:[0,1]
    v_pk_fma_f32 v[214:215], v[212:213], v[196:197], v[214:215] op_sel_hi:[1,0,1]
    v_pk_fma_f32 v[222:223], v[224:225], v[198:199], v[222:223] op_sel_hi:[1,0,1]
    v_cvt_pk_bf16_f32 v69, v212, v214
    v_cvt_pk_bf16_f32 v85, v224, v222
    v_cvt_pk_bf16_f32 v77, v213, v215
    v_cvt_pk_bf16_f32 v93, v225, v223
    v_pk_mul_f32 v[212:213], v[214:215], v[196:197] op_sel:[1,1] op_sel_hi:[0,1] neg_lo:[0,1]
    v_pk_mul_f32 v[218:219], v[222:223], v[198:199] op_sel:[1,1] op_sel_hi:[0,1] neg_lo:[0,1]
    v_pk_fma_f32 v[212:213], v[214:215], v[196:197], v[212:213] op_sel_hi:[1,0,1]
    v_pk_fma_f32 v[218:219], v[222:223], v[198:199], v[218:219] op_sel_hi:[1,0,1]
    v_pk_mul_f32 v[214:215], v[212:213], v[196:197] op_sel:[1,1] op_sel_hi:[0,1] neg_lo:[0,1]
    v_pk_mul_f32 v[222:223], v[218:219], v[198:199] op_sel:[1,1] op_sel_hi:[0,1] neg_lo:[0,1]
    v_pk_fma_f32 v[214:215], v[212:213], v[196:197], v[214:215] op_sel_hi:[1,0,1]
    v_pk_fma_f32 v[222:223], v[218:219], v[198:199], v[222:223] op_sel_hi:[1,0,1]
    v_cvt_pk_bf16_f32 v70, v212, v214
    v_cvt_pk_bf16_f32 v86, v218, v222
    v_cvt_pk_bf16_f32 v78, v213, v215
    v_cvt_pk_bf16_f32 v94, v219, v223
    v_pk_mul_f32 v[212:213], v[214:215], v[196:197] op_sel:[1,1] op_sel_hi:[0,1] neg_lo:[0,1]
    v_pk_mul_f32 v[224:225], v[222:223], v[198:199] op_sel:[1,1] op_sel_hi:[0,1] neg_lo:[0,1]
    v_pk_fma_f32 v[212:213], v[214:215], v[196:197], v[212:213] op_sel_hi:[1,0,1]
    v_pk_fma_f32 v[224:225], v[222:223], v[198:199], v[224:225] op_sel_hi:[1,0,1]
    v_pk_mul_f32 v[214:215], v[212:213], v[196:197] op_sel:[1,1] op_sel_hi:[0,1] neg_lo:[0,1]
    v_pk_mul_f32 v[222:223], v[224:225], v[198:199] op_sel:[1,1] op_sel_hi:[0,1] neg_lo:[0,1]
    v_pk_fma_f32 v[214:215], v[212:213], v[196:197], v[214:215] op_sel_hi:[1,0,1]
    v_pk_fma_f32 v[222:223], v[224:225], v[198:199], v[222:223] op_sel_hi:[1,0,1]
    v_cvt_pk_bf16_f32 v71, v212, v214
    v_cvt_pk_bf16_f32 v87, v224, v222
    v_cvt_pk_bf16_f32 v79, v213, v215
    v_cvt_pk_bf16_f32 v95, v225, v223
    v_pk_mul_f32 v[212:213], v[214:215], v[196:197] op_sel:[1,1] op_sel_hi:[0,1] neg_lo:[0,1]
    v_pk_mul_f32 v[220:221], v[222:223], v[198:199] op_sel:[1,1] op_sel_hi:[0,1] neg_lo:[0,1]
    v_pk_fma_f32 v[212:213], v[214:215], v[196:197], v[212:213] op_sel_hi:[1,0,1]
    v_pk_fma_f32 v[220:221], v[222:223], v[198:199], v[220:221] op_sel_hi:[1,0,1]
    v_pk_mul_f32 v[214:215], v[212:213], v[196:197] op_sel:[1,1] op_sel_hi:[0,1] neg_lo:[0,1]
    v_pk_mul_f32 v[222:223], v[216:217], v[200:201] op_sel:[1,1] op_sel_hi:[0,1] neg_lo:[0,1]
    v_pk_fma_f32 v[214:215], v[212:213], v[196:197], v[214:215] op_sel_hi:[1,0,1]
    v_pk_fma_f32 v[222:223], v[216:217], v[200:201], v[222:223] op_sel_hi:[1,0,1]
    v_cvt_pk_bf16_f32 v72, v212, v214
    v_cvt_pk_bf16_f32 v88, v220, v222
    v_cvt_pk_bf16_f32 v80, v213, v215
    v_cvt_pk_bf16_f32 v96, v221, v223
    v_pk_mul_f32 v[212:213], v[214:215], v[196:197] op_sel:[1,1] op_sel_hi:[0,1] neg_lo:[0,1]
    v_pk_mul_f32 v[224:225], v[218:219], v[200:201] op_sel:[1,1] op_sel_hi:[0,1] neg_lo:[0,1]
    v_pk_fma_f32 v[212:213], v[214:215], v[196:197], v[212:213] op_sel_hi:[1,0,1]
    v_pk_fma_f32 v[224:225], v[218:219], v[200:201], v[224:225] op_sel_hi:[1,0,1]
    v_pk_mul_f32 v[214:215], v[212:213], v[196:197] op_sel:[1,1] op_sel_hi:[0,1] neg_lo:[0,1]
    v_pk_mul_f32 v[216:217], v[220:221], v[200:201] op_sel:[1,1] op_sel_hi:[0,1] neg_lo:[0,1]
    v_pk_fma_f32 v[214:215], v[212:213], v[196:197], v[214:215] op_sel_hi:[1,0,1]
    v_pk_fma_f32 v[216:217], v[220:221], v[200:201], v[216:217] op_sel_hi:[1,0,1]
    v_cvt_pk_bf16_f32 v73, v212, v214
    v_cvt_pk_bf16_f32 v89, v224, v216
    v_cvt_pk_bf16_f32 v81, v213, v215
    v_cvt_pk_bf16_f32 v97, v225, v217
    v_pk_mul_f32 v[212:213], v[214:215], v[196:197] op_sel:[1,1] op_sel_hi:[0,1] neg_lo:[0,1]
    v_pk_mul_f32 v[218:219], v[222:223], v[200:201] op_sel:[1,1] op_sel_hi:[0,1] neg_lo:[0,1]
    v_pk_fma_f32 v[212:213], v[214:215], v[196:197], v[212:213] op_sel_hi:[1,0,1]
    v_pk_fma_f32 v[218:219], v[222:223], v[200:201], v[218:219] op_sel_hi:[1,0,1]
    v_pk_mul_f32 v[214:215], v[212:213], v[196:197] op_sel:[1,1] op_sel_hi:[0,1] neg_lo:[0,1]
    v_pk_mul_f32 v[220:221], v[216:217], v[200:201] op_sel:[1,1] op_sel_hi:[0,1] neg_lo:[0,1]
    v_pk_fma_f32 v[214:215], v[212:213], v[196:197], v[214:215] op_sel_hi:[1,0,1]
    v_pk_fma_f32 v[220:221], v[216:217], v[200:201], v[220:221] op_sel_hi:[1,0,1]
    v_cvt_pk_bf16_f32 v74, v212, v214
    v_cvt_pk_bf16_f32 v90, v218, v220
    v_cvt_pk_bf16_f32 v82, v213, v215
    v_cvt_pk_bf16_f32 v98, v219, v221
    v_pk_mul_f32 v[212:213], v[214:215], v[196:197] op_sel:[1,1] op_sel_hi:[0,1] neg_lo:[0,1]
    v_pk_mul_f32 v[222:223], v[218:219], v[200:201] op_sel:[1,1] op_sel_hi:[0,1] neg_lo:[0,1]
    v_pk_fma_f32 v[212:213], v[214:215], v[196:197], v[212:213] op_sel_hi:[1,0,1]
    v_pk_fma_f32 v[222:223], v[218:219], v[200:201], v[222:223] op_sel_hi:[1,0,1]
    v_pk_mul_f32 v[214:215], v[212:213], v[196:197] op_sel:[1,1] op_sel_hi:[0,1] neg_lo:[0,1]
    v_pk_mul_f32 v[224:225], v[220:221], v[200:201] op_sel:[1,1] op_sel_hi:[0,1] neg_lo:[0,1]
    v_pk_fma_f32 v[214:215], v[212:213], v[196:197], v[214:215] op_sel_hi:[1,0,1]
    v_pk_fma_f32 v[224:225], v[220:221], v[200:201], v[224:225] op_sel_hi:[1,0,1]
    v_cvt_pk_bf16_f32 v75, v212, v214
    v_cvt_pk_bf16_f32 v91, v222, v224
    v_cvt_pk_bf16_f32 v83, v213, v215
    v_cvt_pk_bf16_f32 v99, v223, v225
    v_mfma_f32_32x32x16_bf16 v[100:115], v[68:71], v[32:35], 0
    v_mul_f32 v4, 0x3fb8aa3b, v18
    v_exp_f32 v4, v4
    v_mul_f32 v5, v22, v48
    v_cvt_pk_bf16_f32 v4, v4, v4
    v_mul_f32 v5, 0x3e22f983, v5
    v_lshlrev_b32 v4, 16, v4
    v_mfma_f32_32x32x16_bf16 v[100:115], v[72:75], v[36:39], v[100:115]
    v_mul_f32 v7, v5, v50
    v_mul_f32 v4, v4, v48
    v_mul_f32 v9, v5, v51
    v_mul_f32 v4, 0xbfb8aa3b, v4
    v_rndne_f32 v10, v7
    v_rndne_f32 v11, v9
    v_mfma_f32_32x32x16_bf16 v[132:147], v[84:87], v[40:43], 0
    v_mul_f32 v6, v4, v50
    v_mul_f32 v8, v4, v51
    v_sub_f32 v7, v7, v10
    v_sub_f32 v9, v11, v9
    v_exp_f32 v6, v6
    v_exp_f32 v8, v8
    v_mfma_f32_32x32x16_bf16 v[132:147], v[88:91], v[44:47], v[132:147]
    v_sin_f32 v10, v7
    v_cos_f32 v11, v7
    v_sin_f32 v12, v9
    v_cos_f32 v13, v9
    v_mul_f32 v197, v10, v6
    v_mul_f32_e64 v196, v11, v6
    v_mfma_f32_32x32x16_bf16 v[116:131], v[76:79], v[32:35], 0
    v_mfma_f32_32x32x16_bf16 v[116:131], v[80:83], v[36:39], v[116:131]
    v_cvt_pk_bf16_f32 v164, v100, v101
    v_cvt_pk_bf16_f32 v165, v102, v103
    v_cvt_pk_bf16_f32 v166, v104, v105
    v_cvt_pk_bf16_f32 v167, v106, v107
    v_cvt_pk_bf16_f32 v168, v108, v109
    v_cvt_pk_bf16_f32 v169, v110, v111
    v_mfma_f32_32x32x16_bf16 v[148:163], v[92:95], v[40:43], 0
    v_cvt_pk_bf16_f32 v170, v112, v113
    v_cvt_pk_bf16_f32 v171, v114, v115
    v_cvt_pk_bf16_f32 v180, v132, v133
    v_cvt_pk_bf16_f32 v181, v134, v135
    v_cvt_pk_bf16_f32 v182, v136, v137
    v_cvt_pk_bf16_f32 v183, v138, v139
    v_mfma_f32_32x32x16_bf16 v[148:163], v[96:99], v[44:47], v[148:163]
    v_cvt_pk_bf16_f32 v184, v140, v141
    v_cvt_pk_bf16_f32 v185, v142, v143
    v_cvt_pk_bf16_f32 v186, v144, v145
    v_cvt_pk_bf16_f32 v187, v146, v147
    v_mfma_f32_32x32x16_bf16 v[52:67], v[180:183], v[164:167], v[52:67]
    v_mul_f32 v199, v12, v8
    v_mul_f32 v198, v13, v8
    v_mul_f32 v209, v10, v6
    v_mul_f32 v208, v11, v6
    v_mul_f32 v211, v12, v8
    v_mul_f32 v210, v13, v8
    v_mfma_f32_32x32x16_bf16 v[52:67], v[184:187], v[168:171], v[52:67]
    v_cvt_pk_bf16_f32 v172, v116, v117
    v_cvt_pk_bf16_f32 v173, v118, v119
    v_cvt_pk_bf16_f32 v174, v120, v121
    v_cvt_pk_bf16_f32 v175, v122, v123
    v_cvt_pk_bf16_f32 v176, v124, v125
    v_cvt_pk_bf16_f32 v177, v126, v127
    v_cvt_pk_bf16_f32 v178, v128, v129
    v_cvt_pk_bf16_f32 v179, v130, v131
    v_cvt_pk_bf16_f32 v188, v148, v149
    v_cvt_pk_bf16_f32 v189, v150, v151
    v_cvt_pk_bf16_f32 v190, v152, v153
    v_cvt_pk_bf16_f32 v191, v154, v155
    v_cvt_pk_bf16_f32 v192, v156, v157
    v_cvt_pk_bf16_f32 v193, v158, v159
    v_cvt_pk_bf16_f32 v194, v160, v161
    v_cvt_pk_bf16_f32 v195, v162, v163
    v_mfma_f32_32x32x16_bf16 v[52:67], v[188:191], v[172:175], v[52:67]
    v_mul_f32 v4, v26, v49
    v_mul_f32 v5, v30, v49
    v_permlane32_swap_b32 v197, v209
    v_permlane32_swap_b32 v196, v208
    v_permlane32_swap_b32 v199, v211
    v_permlane32_swap_b32 v198, v210
    v_mfma_f32_32x32x16_bf16 v[52:67], v[192:195], v[176:179], v[52:67]
    v_cndmask_b32 v212, 1.0, v208, s[74:75]
    v_cndmask_b32 v213, 0, v209, s[74:75]
    v_cndmask_b32 v6, 1.0, v210, s[74:75]
    v_cndmask_b32 v7, 0, v211, s[74:75]
    v_mul_f32 v200, v210, v210
    v_add_f32 v8, v210, v210
    v_fma_f32 v200, -v211, v211, v200
    v_mul_f32 v201, v8, v211
    v_mul_f32 v216, v4, v6
    v_mul_f32 v217, v4, v7
    v_fmac_f32 v216, v5, v7
    v_fma_f32 v217, -v5, v6, v217
    v_pk_mul_f32 v[214:215], v[212:213], v[196:197] op_sel:[1,1] op_sel_hi:[0,1] neg_lo:[0,1]
    v_pk_mul_f32 v[222:223], v[216:217], v[198:199] op_sel:[1,1] op_sel_hi:[0,1] neg_lo:[0,1]
    v_pk_fma_f32 v[214:215], v[212:213], v[196:197], v[214:215] op_sel_hi:[1,0,1]
    v_pk_fma_f32 v[222:223], v[216:217], v[198:199], v[222:223] op_sel_hi:[1,0,1]
    v_cvt_pk_bf16_f32 v68, v212, v214
    v_cvt_pk_bf16_f32 v84, v216, v222
    v_cvt_pk_bf16_f32 v76, v213, v215
    v_cvt_pk_bf16_f32 v92, v217, v223
    v_pk_mul_f32 v[212:213], v[214:215], v[196:197] op_sel:[1,1] op_sel_hi:[0,1] neg_lo:[0,1]
    v_pk_mul_f32 v[224:225], v[222:223], v[198:199] op_sel:[1,1] op_sel_hi:[0,1] neg_lo:[0,1]
    v_pk_fma_f32 v[212:213], v[214:215], v[196:197], v[212:213] op_sel_hi:[1,0,1]
    v_pk_fma_f32 v[224:225], v[222:223], v[198:199], v[224:225] op_sel_hi:[1,0,1]
    v_pk_mul_f32 v[214:215], v[212:213], v[196:197] op_sel:[1,1] op_sel_hi:[0,1] neg_lo:[0,1]
    v_pk_mul_f32 v[222:223], v[224:225], v[198:199] op_sel:[1,1] op_sel_hi:[0,1] neg_lo:[0,1]
    v_pk_fma_f32 v[214:215], v[212:213], v[196:197], v[214:215] op_sel_hi:[1,0,1]
    v_pk_fma_f32 v[222:223], v[224:225], v[198:199], v[222:223] op_sel_hi:[1,0,1]
    v_cvt_pk_bf16_f32 v69, v212, v214
    v_cvt_pk_bf16_f32 v85, v224, v222
    v_cvt_pk_bf16_f32 v77, v213, v215
    v_cvt_pk_bf16_f32 v93, v225, v223
    v_pk_mul_f32 v[212:213], v[214:215], v[196:197] op_sel:[1,1] op_sel_hi:[0,1] neg_lo:[0,1]
    v_pk_mul_f32 v[218:219], v[222:223], v[198:199] op_sel:[1,1] op_sel_hi:[0,1] neg_lo:[0,1]
    v_pk_fma_f32 v[212:213], v[214:215], v[196:197], v[212:213] op_sel_hi:[1,0,1]
    v_pk_fma_f32 v[218:219], v[222:223], v[198:199], v[218:219] op_sel_hi:[1,0,1]
    v_pk_mul_f32 v[214:215], v[212:213], v[196:197] op_sel:[1,1] op_sel_hi:[0,1] neg_lo:[0,1]
    v_pk_mul_f32 v[222:223], v[218:219], v[198:199] op_sel:[1,1] op_sel_hi:[0,1] neg_lo:[0,1]
    v_pk_fma_f32 v[214:215], v[212:213], v[196:197], v[214:215] op_sel_hi:[1,0,1]
    v_pk_fma_f32 v[222:223], v[218:219], v[198:199], v[222:223] op_sel_hi:[1,0,1]
    v_cvt_pk_bf16_f32 v70, v212, v214
    v_cvt_pk_bf16_f32 v86, v218, v222
    v_cvt_pk_bf16_f32 v78, v213, v215
    v_cvt_pk_bf16_f32 v94, v219, v223
    v_pk_mul_f32 v[212:213], v[214:215], v[196:197] op_sel:[1,1] op_sel_hi:[0,1] neg_lo:[0,1]
    v_pk_mul_f32 v[224:225], v[222:223], v[198:199] op_sel:[1,1] op_sel_hi:[0,1] neg_lo:[0,1]
    v_pk_fma_f32 v[212:213], v[214:215], v[196:197], v[212:213] op_sel_hi:[1,0,1]
    v_pk_fma_f32 v[224:225], v[222:223], v[198:199], v[224:225] op_sel_hi:[1,0,1]
    v_pk_mul_f32 v[214:215], v[212:213], v[196:197] op_sel:[1,1] op_sel_hi:[0,1] neg_lo:[0,1]
    v_pk_mul_f32 v[222:223], v[224:225], v[198:199] op_sel:[1,1] op_sel_hi:[0,1] neg_lo:[0,1]
    v_pk_fma_f32 v[214:215], v[212:213], v[196:197], v[214:215] op_sel_hi:[1,0,1]
    v_pk_fma_f32 v[222:223], v[224:225], v[198:199], v[222:223] op_sel_hi:[1,0,1]
    v_cvt_pk_bf16_f32 v71, v212, v214
    v_cvt_pk_bf16_f32 v87, v224, v222
    v_cvt_pk_bf16_f32 v79, v213, v215
    v_cvt_pk_bf16_f32 v95, v225, v223
    v_pk_mul_f32 v[212:213], v[214:215], v[196:197] op_sel:[1,1] op_sel_hi:[0,1] neg_lo:[0,1]
    v_pk_mul_f32 v[220:221], v[222:223], v[198:199] op_sel:[1,1] op_sel_hi:[0,1] neg_lo:[0,1]
    v_pk_fma_f32 v[212:213], v[214:215], v[196:197], v[212:213] op_sel_hi:[1,0,1]
    v_pk_fma_f32 v[220:221], v[222:223], v[198:199], v[220:221] op_sel_hi:[1,0,1]
    v_pk_mul_f32 v[214:215], v[212:213], v[196:197] op_sel:[1,1] op_sel_hi:[0,1] neg_lo:[0,1]
    v_pk_mul_f32 v[222:223], v[216:217], v[200:201] op_sel:[1,1] op_sel_hi:[0,1] neg_lo:[0,1]
    v_pk_fma_f32 v[214:215], v[212:213], v[196:197], v[214:215] op_sel_hi:[1,0,1]
    v_pk_fma_f32 v[222:223], v[216:217], v[200:201], v[222:223] op_sel_hi:[1,0,1]
    v_cvt_pk_bf16_f32 v72, v212, v214
    v_cvt_pk_bf16_f32 v88, v220, v222
    v_cvt_pk_bf16_f32 v80, v213, v215
    v_cvt_pk_bf16_f32 v96, v221, v223
    v_pk_mul_f32 v[212:213], v[214:215], v[196:197] op_sel:[1,1] op_sel_hi:[0,1] neg_lo:[0,1]
    v_pk_mul_f32 v[224:225], v[218:219], v[200:201] op_sel:[1,1] op_sel_hi:[0,1] neg_lo:[0,1]
    v_pk_fma_f32 v[212:213], v[214:215], v[196:197], v[212:213] op_sel_hi:[1,0,1]
    v_pk_fma_f32 v[224:225], v[218:219], v[200:201], v[224:225] op_sel_hi:[1,0,1]
    v_pk_mul_f32 v[214:215], v[212:213], v[196:197] op_sel:[1,1] op_sel_hi:[0,1] neg_lo:[0,1]
    v_pk_mul_f32 v[216:217], v[220:221], v[200:201] op_sel:[1,1] op_sel_hi:[0,1] neg_lo:[0,1]
    v_pk_fma_f32 v[214:215], v[212:213], v[196:197], v[214:215] op_sel_hi:[1,0,1]
    v_pk_fma_f32 v[216:217], v[220:221], v[200:201], v[216:217] op_sel_hi:[1,0,1]
    v_cvt_pk_bf16_f32 v73, v212, v214
    v_cvt_pk_bf16_f32 v89, v224, v216
    v_cvt_pk_bf16_f32 v81, v213, v215
    v_cvt_pk_bf16_f32 v97, v225, v217
    v_pk_mul_f32 v[212:213], v[214:215], v[196:197] op_sel:[1,1] op_sel_hi:[0,1] neg_lo:[0,1]
    v_pk_mul_f32 v[218:219], v[222:223], v[200:201] op_sel:[1,1] op_sel_hi:[0,1] neg_lo:[0,1]
    v_pk_fma_f32 v[212:213], v[214:215], v[196:197], v[212:213] op_sel_hi:[1,0,1]
    v_pk_fma_f32 v[218:219], v[222:223], v[200:201], v[218:219] op_sel_hi:[1,0,1]
    v_pk_mul_f32 v[214:215], v[212:213], v[196:197] op_sel:[1,1] op_sel_hi:[0,1] neg_lo:[0,1]
    v_pk_mul_f32 v[220:221], v[216:217], v[200:201] op_sel:[1,1] op_sel_hi:[0,1] neg_lo:[0,1]
    v_pk_fma_f32 v[214:215], v[212:213], v[196:197], v[214:215] op_sel_hi:[1,0,1]
    v_pk_fma_f32 v[220:221], v[216:217], v[200:201], v[220:221] op_sel_hi:[1,0,1]
    v_cvt_pk_bf16_f32 v74, v212, v214
    v_cvt_pk_bf16_f32 v90, v218, v220
    v_cvt_pk_bf16_f32 v82, v213, v215
    v_cvt_pk_bf16_f32 v98, v219, v221
    v_pk_mul_f32 v[212:213], v[214:215], v[196:197] op_sel:[1,1] op_sel_hi:[0,1] neg_lo:[0,1]
    v_pk_mul_f32 v[222:223], v[218:219], v[200:201] op_sel:[1,1] op_sel_hi:[0,1] neg_lo:[0,1]
    v_pk_fma_f32 v[212:213], v[214:215], v[196:197], v[212:213] op_sel_hi:[1,0,1]
    v_pk_fma_f32 v[222:223], v[218:219], v[200:201], v[222:223] op_sel_hi:[1,0,1]
    v_pk_mul_f32 v[214:215], v[212:213], v[196:197] op_sel:[1,1] op_sel_hi:[0,1] neg_lo:[0,1]
    v_pk_mul_f32 v[224:225], v[220:221], v[200:201] op_sel:[1,1] op_sel_hi:[0,1] neg_lo:[0,1]
    v_pk_fma_f32 v[214:215], v[212:213], v[196:197], v[214:215] op_sel_hi:[1,0,1]
    v_pk_fma_f32 v[224:225], v[220:221], v[200:201], v[224:225] op_sel_hi:[1,0,1]
    v_cvt_pk_bf16_f32 v75, v212, v214
    v_cvt_pk_bf16_f32 v91, v222, v224
    v_cvt_pk_bf16_f32 v83, v213, v215
    v_cvt_pk_bf16_f32 v99, v223, v225
    v_mfma_f32_32x32x16_bf16 v[100:115], v[68:71], v[32:35], 0
    v_mfma_f32_32x32x16_bf16 v[100:115], v[72:75], v[36:39], v[100:115]
    v_mfma_f32_32x32x16_bf16 v[132:147], v[84:87], v[40:43], 0
    v_mfma_f32_32x32x16_bf16 v[132:147], v[88:91], v[44:47], v[132:147]
    v_mfma_f32_32x32x16_bf16 v[116:131], v[76:79], v[32:35], 0
    v_mfma_f32_32x32x16_bf16 v[116:131], v[80:83], v[36:39], v[116:131]
    s_nop 7
    s_nop 0
    v_cvt_pk_bf16_f32 v164, v100, v101
    v_cvt_pk_bf16_f32 v165, v102, v103
    v_cvt_pk_bf16_f32 v166, v104, v105
    v_cvt_pk_bf16_f32 v167, v106, v107
    v_cvt_pk_bf16_f32 v168, v108, v109
    v_cvt_pk_bf16_f32 v169, v110, v111
    v_mfma_f32_32x32x16_bf16 v[148:163], v[92:95], v[40:43], 0
    v_cvt_pk_bf16_f32 v170, v112, v113
    v_cvt_pk_bf16_f32 v171, v114, v115
    v_cvt_pk_bf16_f32 v180, v132, v133
    v_cvt_pk_bf16_f32 v181, v134, v135
    v_cvt_pk_bf16_f32 v182, v136, v137
    v_cvt_pk_bf16_f32 v183, v138, v139
    v_mfma_f32_32x32x16_bf16 v[148:163], v[96:99], v[44:47], v[148:163]
    v_cvt_pk_bf16_f32 v184, v140, v141
    v_cvt_pk_bf16_f32 v185, v142, v143
    v_cvt_pk_bf16_f32 v186, v144, v145
    v_cvt_pk_bf16_f32 v187, v146, v147
    v_mfma_f32_32x32x16_bf16 v[52:67], v[180:183], v[164:167], v[52:67]
    v_cvt_pk_bf16_f32 v172, v116, v117
    v_cvt_pk_bf16_f32 v173, v118, v119
    v_cvt_pk_bf16_f32 v174, v120, v121
PADS1:
    s_cbranch_execz WR3
    s_nop 0
    v_cvt_pk_bf16_f32 v175, v122, v123
    v_cvt_pk_bf16_f32 v176, v124, v125
    v_cvt_pk_bf16_f32 v177, v126, v127
    v_mfma_f32_32x32x16_bf16 v[52:67], v[184:187], v[168:171], v[52:67]
    v_cvt_pk_bf16_f32 v178, v128, v129
    v_cvt_pk_bf16_f32 v179, v130, v131
    v_cvt_pk_bf16_f32 v188, v148, v149
    v_cvt_pk_bf16_f32 v189, v150, v151
    v_cvt_pk_bf16_f32 v190, v152, v153
    v_cvt_pk_bf16_f32 v191, v154, v155
    v_cvt_pk_bf16_f32 v192, v156, v157
    v_cvt_pk_bf16_f32 v193, v158, v159
    v_cvt_pk_bf16_f32 v194, v160, v161
    v_cvt_pk_bf16_f32 v195, v162, v163
    v_mfma_f32_32x32x16_bf16 v[52:67], v[188:191], v[172:175], v[52:67]
    s_nop 0
    v_mfma_f32_32x32x16_bf16 v[52:67], v[192:195], v[176:179], v[52:67]
    s_cmp_eq_u32 s37, 0
    s_cbranch_scc0 NB8
    s_barrier
NB8:
    v_and_b32 v9, 15, v1
    v_lshrrev_b32 v10, 4, v1
    v_and_b32 v11, 1, v1
    v_xor_b32 v11, 1, v11
    v_mul_u32_u24 v11, 4162, v11
    v_lshl_add_u32 v11, v10, 4, v11
    v_lshlrev_b32 v12, 1, v9
    v_sub_u32 v11, v11, v12
    s_lshl_b32 s76, s60, 8
    s_sub_u32 s76, s38, s76
    s_add_u32 s76, s76, 3358
    v_add_u32_e64 v176, s76, v11
    v_add_u32 v177, -1024, v176
    v_add_u32 v178, -2048, v176
    v_add_u32 v179, -3072, v176
    v_lshl_add_u32 v9, v9, 1, v10
    s_lshl_b32 s76, s60, 4
    s_sub_u32 s76, 30, s76
    v_add_u32 v9, s76, v9
    v_add_u32 v10, 0, v9
    v_and_b32 v11, 32, v10
    v_add_u32 v10, v10, v11
    v_lshl_add_u32 v186, v10, 4, s39
    v_add_u32 v10, -4, v9
    v_and_b32 v11, 32, v10
    v_add_u32 v10, v10, v11
    v_lshl_add_u32 v187, v10, 4, s39
    v_add_u32 v10, -8, v9
    v_and_b32 v11, 32, v10
    v_add_u32 v10, v10, v11
    v_lshl_add_u32 v188, v10, 4, s39
    v_add_u32 v10, -12, v9
    v_and_b32 v11, 32, v10
    v_add_u32 v10, v10, v11
    v_lshl_add_u32 v189, v10, 4, s39
    s_and_b32 s3, s34, 3
    s_lshr_b32 s76, s61, 1
    s_lshl_b32 s76, s76, 13
    s_lshl_b32 s77, s3, 11
    s_add_u32 s26, s76, s77
    s_and_b32 s76, s61, 1
    s_lshl_b32 s76, s76, 9
    s_sub_u32 s27, s39, s76
    s_add_u32 s27, s27, s77
    s_add_u32 s27, s27, 1024
    v_and_b32 v181, 31, v1
    v_lshlrev_b32 v181, 5, v181
    v_lshrrev_b32 v182, 5, v1
    v_lshl_add_u32 v181, v182, 4, v181
    v_lshlrev_b32 v182, 4, v1
    v_and_b32 v184, 15, v1
    v_lshlrev_b32 v184, 7, v184
    s_add_u32 s20, s77, 13664256
    s_cmp_eq_u32 s37, 0
    s_cbranch_scc0 NG9
    s_setprio 0
    s_barrier
    s_mul_i32 s68, s36, 43
    s_lshr_b32 s68, s68, 8
    s_mul_i32 s69, s68, 6
    s_sub_u32 s69, s36, s69
    s_lshr_b32 s64, s35, 1
    s_and_b32 s65, s35, 1
    s_lshl_b32 s28, s64, 2
    s_add_u32 s28, s28, s68
    s_mul_i32 s29, s65, 6
    s_add_u32 s29, s29, s69
    s_mov_b32 s30, 5
    s_add_u32 s64, s64, 1
    s_mul_i32 s66, s68, 32
    s_lshr_b32 s66, s66, 4
    s_add_u32 s30, s30, s66
    s_mul_i32 s66, s69, 27
    s_lshr_b32 s66, s66, 4
    s_add_u32 s30, s30, s66
    s_mul_i32 s66, s64, 40
    s_lshr_b32 s66, s66, 4
    s_add_u32 s30, s30, s66
    s_mul_i32 s66, s30, 26
    s_lshr_b32 s66, s66, 8
    s_mul_i32 s66, s66, 10
    s_sub_u32 s30, s30, s66
    s_lshl_b32 s76, s28, 7
    s_lshl_b32 s77, s3, 5
    s_add_u32 s76, s76, s77
    s_mul_i32 s76, s76, 1280
    v_lshrrev_b32 v9, 3, v1
    v_mul_u32_u24 v9, 1280, v9
    v_lshrrev_b32 v10, 4, v1
    v_xor_b32 v11, v10, v1
    v_and_b32 v11, 7, v11
    v_lshl_add_u32 v9, v11, 4, v9
    v_add_u32 v16, s76, v9
    v_xor_b32 v9, 64, v16
    v_add_u32 v17, 9216, v9
    v_add_u32 v18, 18432, v16
    v_add_u32 v19, 27648, v9
    s_mul_i32 s76, s3, 49152
    s_lshl_b32 s77, s29, 8
    s_add_u32 s76, s76, s77
    v_mul_u32_u24 v9, 3072, v10
    v_lshlrev_b32 v11, 2, v10
    v_xor_b32 v11, v11, v1
    v_and_b32 v11, 15, v11
    v_lshl_add_u32 v9, v11, 4, v9
    v_add_u32 v20, s76, v9
    v_xor_b32_e64 v9, 16, v20
    v_add_u32 v21, 11264, v20
    v_add_u32 v22, 22528, v9
    v_add_u32 v23, 33792, v9
    s_lshl_b32 s67, s3, 12
    s_barrier
    s_add_u32 m0, s67, 16384
    s_lshl_b32 s76, s30, 7
    s_nop 0
    buffer_load_dwordx4 v16, s[40:43], s76 offen offset:0 lds
    buffer_load_dwordx4 v17, s[40:43], s76 offen offset:1024 lds
    buffer_load_dwordx4 v18, s[40:43], s76 offen offset:2048 lds
    buffer_load_dwordx4 v19, s[40:43], s76 offen offset:3072 lds
    s_add_u32 m0, s67, 81920
    s_mul_i32 s77, s30, 196608
    buffer_load_dwordx4 v20, s[44:47], s77 offen offset:0 lds
    buffer_load_dwordx4 v21, s[44:47], s77 offen offset:1024 lds
    buffer_load_dwordx4 v22, s[44:47], s77 offen offset:2048 lds
    buffer_load_dwordx4 v23, s[44:47], s77 offen offset:3072 lds
    s_add_u32 s30, s30, 1
    s_cmp_eq_u32 s30, 10
    s_cselect_b32 s30, 0, s30
    s_cmp_ge_u32 s36, 10
    s_cselect_b32 s62, 1, 0
    s_mul_i32 s63, s62, 10
    s_sub_u32 s63, s36, s63
    s_lshl_b32 s66, s35, 1
    s_add_u32 s62, s62, s66
    s_lshl_b32 s76, s62, 7
    s_lshl_b32 s77, s3, 5
    s_add_u32 s76, s76, s77
    s_mul_i32 s16, s76, 1280
    s_min_u32 s76, s63, 9
    s_lshl_b32 s76, s76, 7
    s_add_u32 s16, s16, s76
    v_lshrrev_b32 v9, 3, v1
    v_mul_u32_u24 v9, 1280, v9
    v_lshrrev_b32 v10, 4, v1
    v_xor_b32 v10, v10, v1
    v_and_b32 v10, 7, v10
    v_lshl_add_u32 v9, v10, 4, v9
    v_xor_b32 v10, 64, v9
    s_mul_i32 s17, s3, 4160
    s_add_u32 s17, s17, 131072
    s_mov_b32 m0, s17
    s_add_u32 s76, s16, 0
    buffer_load_dwordx4 v9, s[40:43], s76 offen offset:0 lds
    s_barrier
    s_add_u32 m0, s67, 32768
    s_lshl_b32 s76, s30, 7
    buffer_load_dwordx4 v16, s[40:43], s76 offen offset:0 lds
    buffer_load_dwordx4 v17, s[40:43], s76 offen offset:1024 lds
    buffer_load_dwordx4 v18, s[40:43], s76 offen offset:2048 lds
    buffer_load_dwordx4 v19, s[40:43], s76 offen offset:3072 lds
    s_add_u32 m0, s67, 98304
    s_mul_i32 s77, s30, 196608
    buffer_load_dwordx4 v20, s[44:47], s77 offen offset:0 lds
    buffer_load_dwordx4 v21, s[44:47], s77 offen offset:1024 lds
    buffer_load_dwordx4 v22, s[44:47], s77 offen offset:2048 lds
    buffer_load_dwordx4 v23, s[44:47], s77 offen offset:3072 lds
    s_add_u32 s30, s30, 1
    s_cmp_eq_u32 s30, 10
    s_cselect_b32 s30, 0, s30
    s_mov_b32 m0, s17
    s_add_u32 s76, s16, 9216
    buffer_load_dwordx4 v10, s[40:43], s76 offen offset:1024 lds
    s_lshl_b32 s76, s28, 2
    s_add_u32 s76, s76, s3
    s_lshl_b32 s77, s3, 4
    s_lshl_b32 s18, s65, 3
    s_add_u32 s77, s77, s18
    s_add_u32 s77, s77, s69
    s_sub_u32 s77, s77, s76
    v_and_b32 v185, 1, v1
    v_mul_i32_i24 v185, s77, v185
    v_add_u32 v185, s76, v185
    v_lshlrev_b32 v185, 7, v185
    s_mov_b32 s18, 13672448
    s_lshr_b32 s76, s3, 1
    s_mul_i32 s76, s76, 983040
    s_and_b32 s77, s3, 1
    s_mul_i32 s77, s77, 20480
    s_add_u32 s76, s76, s77
    s_lshl_b32 s77, s63, 7
    s_add_u32 s76, s76, s77
    v_lshrrev_b32 v13, 3, v1
    v_mul_u32_u24 v14, 1280, v13
    v_lshrrev_b32 v13, 4, v1
    v_lshlrev_b32 v13, 1, v13
    v_xor_b32 v13, v13, v1
    v_and_b32 v13, 7, v13
    v_lshl_add_u32 v14, v13, 4, v14
    v_add_u32 v14, s76, v14
    v_add_u32 v15, 9216, v14
    s_lshl_b32 s78, s3, 11
    s_cmp_lt_u32 s36, 20
    s_cselect_b32 s76, 0, 0x40000000
    v_add_u32 v14, s76, v14
    v_add_u32 v15, s76, v15
    s_barrier
    s_add_u32 m0, s67, 49152
    s_lshl_b32 s76, s30, 7
    s_nop 0
    buffer_load_dwordx4 v16, s[40:43], s76 offen offset:0 lds
    buffer_load_dwordx4 v17, s[40:43], s76 offen offset:1024 lds
    buffer_load_dwordx4 v18, s[40:43], s76 offen offset:2048 lds
    buffer_load_dwordx4 v19, s[40:43], s76 offen offset:3072 lds
    s_add_u32 m0, s67, 114688
    s_mul_i32 s77, s30, 196608
    buffer_load_dwordx4 v20, s[44:47], s77 offen offset:0 lds
    buffer_load_dwordx4 v21, s[44:47], s77 offen offset:1024 lds
    buffer_load_dwordx4 v22, s[44:47], s77 offen offset:2048 lds
    buffer_load_dwordx4 v23, s[44:47], s77 offen offset:3072 lds
    s_add_u32 s30, s30, 1
    s_cmp_eq_u32 s30, 10
    s_cselect_b32 s30, 0, s30
    s_mov_b32 m0, s17
    s_add_u32 s76, s16, 18432
    buffer_load_dwordx4 v9, s[40:43], s76 offen offset:2048 lds
    s_mul_i32 s4, s63, 77
    s_lshr_b32 s4, s4, 6
    s_lshl_b32 s4, s4, 10
    s_add_u32 s5, s4, 1024
    s_cmp_eq_u32 s5, 12288
    s_cselect_b32 s5, 0, s5
    s_add_u32 s6, s5, 1024
    s_cmp_eq_u32 s6, 12288
    s_cselect_b32 s6, 0, s6
    s_add_u32 s7, s6, 1024
    s_cmp_eq_u32 s7, 12288
    s_cselect_b32 s7, 0, s7
    s_add_u32 s8, s7, 1024
    s_cmp_eq_u32 s8, 12288
    s_cselect_b32 s8, 0, s8
    s_add_u32 s9, s8, 1024
    s_cmp_eq_u32 s9, 12288
    s_cselect_b32 s9, 0, s9
    s_add_u32 s10, s9, 1024
    s_cmp_eq_u32 s10, 12288
    s_cselect_b32 s10, 0, s10
    s_add_u32 s11, s10, 1024
    s_cmp_eq_u32 s11, 12288
    s_cselect_b32 s11, 0, s11
    s_add_u32 s12, s11, 1024
    s_cmp_eq_u32 s12, 12288
    s_cselect_b32 s12, 0, s12
    s_add_u32 s13, s12, 1024
    s_cmp_eq_u32 s13, 12288
    s_cselect_b32 s13, 0, s13
    s_add_u32 s14, s13, 1024
    s_cmp_eq_u32 s14, 12288
    s_cselect_b32 s14, 0, s14
    s_add_u32 s15, s14, 1024
    s_cmp_eq_u32 s15, 12288
    s_cselect_b32 s15, 0, s15
    s_waitcnt vmcnt(19)
    s_barrier
    s_add_u32 m0, s67, 0
    s_lshl_b32 s76, s30, 7
    s_nop 0
    buffer_load_dwordx4 v16, s[40:43], s76 offen offset:0 lds
    buffer_load_dwordx4 v17, s[40:43], s76 offen offset:1024 lds
    buffer_load_dwordx4 v18, s[40:43], s76 offen offset:2048 lds
    buffer_load_dwordx4 v19, s[40:43], s76 offen offset:3072 lds
    s_add_u32 m0, s67, 65536
    s_mul_i32 s77, s30, 196608
    buffer_load_dwordx4 v20, s[44:47], s77 offen offset:0 lds
    buffer_load_dwordx4 v21, s[44:47], s77 offen offset:1024 lds
    buffer_load_dwordx4 v22, s[44:47], s77 offen offset:2048 lds
    buffer_load_dwordx4 v23, s[44:47], s77 offen offset:3072 lds
    s_add_u32 s30, s30, 1
    s_cmp_eq_u32 s30, 10
    s_cselect_b32 s30, 0, s30
    s_mov_b32 m0, s17
    s_add_u32 s76, s16, 27648
    buffer_load_dwordx4 v10, s[40:43], s76 offen offset:3072 lds
    s_waitcnt vmcnt(19)
    s_barrier
    buffer_load_dword v183, v185, s[52:55], s18 offen sc1
    s_add_u32 m0, s67, 16384
    s_lshl_b32 s76, s30, 7
    s_nop 0
    buffer_load_dwordx4 v16, s[40:43], s76 offen offset:0 lds
    buffer_load_dwordx4 v17, s[40:43], s76 offen offset:1024 lds
    buffer_load_dwordx4 v18, s[40:43], s76 offen offset:2048 lds
    buffer_load_dwordx4 v19, s[40:43], s76 offen offset:3072 lds
    s_add_u32 m0, s67, 81920
    s_mul_i32 s77, s30, 196608
    buffer_load_dwordx4 v20, s[44:47], s77 offen offset:0 lds
    buffer_load_dwordx4 v21, s[44:47], s77 offen offset:1024 lds
    buffer_load_dwordx4 v22, s[44:47], s77 offen offset:2048 lds
    buffer_load_dwordx4 v23, s[44:47], s77 offen offset:3072 lds
    s_add_u32 s30, s30, 1
    s_cmp_eq_u32 s30, 10
    s_cselect_b32 s30, 0, s30
    s_waitcnt vmcnt(9)
    s_barrier
    s_waitcnt vmcnt(8)
    v_cmp_ne_u32 vcc, s21, v183
    s_nop 0
    s_cbranch_vccz OK13
    s_mov_b32 s79, 0
P14:
    buffer_load_dword v183, v185, s[52:55], s18 offen sc1
    s_add_u32 s79, s79, 1
    s_waitcnt vmcnt(0)
    v_cmp_ne_u32 vcc, s21, v183
    s_nop 0
    s_cbranch_vccz PE15
    s_sleep 4
    s_cmp_gt_u32 s79, 32768
    s_cbranch_scc0 P14
PE15:
OK13:
    s_lshl_b32 s76, s3, 11
    s_add_u32 m0, s76, 148736
    s_lshl_b32 s76, s29, 2
    s_add_u32 s76, s76, s3
    s_lshl_b32 s76, s76, 11
    s_add_u32 s76, s76, 14155776
    buffer_load_dwordx4 v182, s[52:55], s76 offen sc1 lds
    buffer_load_dwordx4 v182, s[52:55], s76 offen offset:1024 sc1 lds
    s_lshl_b32 s77, s3, 10
    s_add_u32 m0, s77, 156928
    s_lshl_b32 s76, s28, 12
    s_add_u32 s76, s76, s77
    s_add_u32 s76, s76, 14090240
    buffer_load_dwordx4 v182, s[52:55], s76 offen sc1 lds
    s_add_u32 m0, s78, 98304
    s_mul_i32 s76, s13, 80
    s_add_u32 s76, s76, 40960
    buffer_load_dwordx4 v14, s[48:51], s76 offen lds
    buffer_load_dwordx4 v15, s[48:51], s76 offen offset:1024 lds
    s_add_u32 m0, s78, 106496
    s_mul_i32 s76, s15, 80
    s_add_u32 s76, s76, 40960
    buffer_load_dwordx4 v14, s[48:51], s76 offen lds
    buffer_load_dwordx4 v15, s[48:51], s76 offen offset:1024 lds
    s_barrier
    s_nop 0
    s_add_u32 m0, s78, 32768
    s_mul_i32 s76, s11, 80
    s_add_u32 s76, s76, 40960
    buffer_load_dwordx4 v14, s[48:51], s76 offen lds
    buffer_load_dwordx4 v15, s[48:51], s76 offen offset:1024 lds
    s_add_u32 m0, s78, 40960
    s_mul_i32 s76, s12, 80
    s_add_u32 s76, s76, 40960
    buffer_load_dwordx4 v14, s[48:51], s76 offen lds
    buffer_load_dwordx4 v15, s[48:51], s76 offen offset:1024 lds
    s_add_u32 m0, s78, 114688
    s_mul_i32 s76, s14, 80
    s_add_u32 s76, s76, 40960
    buffer_load_dwordx4 v14, s[48:51], s76 offen lds
    buffer_load_dwordx4 v15, s[48:51], s76 offen offset:1024 lds
    s_waitcnt vmcnt(10)
    s_barrier
    buffer_load_dword v183, v184, s[52:55], s20 offen sc1
    s_add_u32 m0, s78, 122880
    s_mul_i32 s76, s5, 80
    buffer_load_dwordx4 v14, s[48:51], s76 offen lds
    buffer_load_dwordx4 v15, s[48:51], s76 offen offset:1024 lds
    s_add_u32 m0, s78, 49152
    s_mul_i32 s76, s10, 80
    s_add_u32 s76, s76, 40960
    buffer_load_dwordx4 v14, s[48:51], s76 offen lds
    buffer_load_dwordx4 v15, s[48:51], s76 offen offset:1024 lds
    s_add_u32 m0, s78, 57344
    s_mul_i32 s76, s4, 80
    buffer_load_dwordx4 v14, s[48:51], s76 offen lds
    buffer_load_dwordx4 v15, s[48:51], s76 offen offset:1024 lds
    s_add_u32 m0, s78, 0
    s_mul_i32 s76, s6, 80
    buffer_load_dwordx4 v14, s[48:51], s76 offen lds
    buffer_load_dwordx4 v15, s[48:51], s76 offen offset:1024 lds
    s_waitcnt vmcnt(11)
    s_barrier
    s_waitcnt vmcnt(8)
    v_cmp_ne_u32 vcc, s21, v183
    s_nop 0
    s_cbranch_vccz OK16
    s_mov_b32 s79, 0
P17:
    buffer_load_dword v183, v184, s[52:55], s20 offen sc1
    s_add_u32 s79, s79, 1
    s_waitcnt vmcnt(0)
    v_cmp_ne_u32 vcc, s21, v183
    s_nop 0
    s_cbranch_vccz PE18
    s_sleep 4
    s_cmp_gt_u32 s79, 32768
    s_cbranch_scc0 P17
PE18:
OK16:
    s_mov_b32 m0, s27
    s_nop 0
    s_nop 0
    buffer_load_dwordx4 v181, s[52:55], s26 offen sc1 lds
    buffer_load_dwordx4 v181, s[52:55], s26 offen offset:1024 sc1 lds
    s_add_u32 m0, s78, 8192
    s_mul_i32 s76, s7, 80
    buffer_load_dwordx4 v14, s[48:51], s76 offen lds
    buffer_load_dwordx4 v15, s[48:51], s76 offen offset:1024 lds
    s_add_u32 m0, s78, 65536
    s_mul_i32 s76, s10, 80
    buffer_load_dwordx4 v14, s[48:51], s76 offen lds
    buffer_load_dwordx4 v15, s[48:51], s76 offen offset:1024 lds
    s_waitcnt vmcnt(8)
    s_barrier
    s_add_u32 m0, s78, 73728
    s_mul_i32 s76, s11, 80
    buffer_load_dwordx4 v14, s[48:51], s76 offen lds
    buffer_load_dwordx4 v15, s[48:51], s76 offen offset:1024 lds
    s_add_u32 m0, s78, 16384
    s_mul_i32 s76, s8, 80
    buffer_load_dwordx4 v14, s[48:51], s76 offen lds
    buffer_load_dwordx4 v15, s[48:51], s76 offen offset:1024 lds
    s_add_u32 m0, s78, 24576
    s_mul_i32 s76, s9, 80
    buffer_load_dwordx4 v14, s[48:51], s76 offen lds
    buffer_load_dwordx4 v15, s[48:51], s76 offen offset:1024 lds
    s_add_u32 m0, s78, 81920
    s_mul_i32 s76, s12, 80
    buffer_load_dwordx4 v14, s[48:51], s76 offen lds
    buffer_load_dwordx4 v15, s[48:51], s76 offen offset:1024 lds
    s_add_u32 m0, s78, 90112
    s_mul_i32 s76, s13, 80
    buffer_load_dwordx4 v14, s[48:51], s76 offen lds
    buffer_load_dwordx4 v15, s[48:51], s76 offen offset:1024 lds
    s_waitcnt vmcnt(4)
    s_branch NW10
NG9:
    buffer_load_dword v183, v184, s[52:55], s20 offen sc1
NW10:
    s_setprio 2
    ds_write_b128 v202, v[52:55] offset:0
    ds_write_b128 v202, v[56:59] offset:1024
    ds_write_b128 v202, v[60:63] offset:2048
    ds_write_b128 v202, v[64:67] offset:3072
    s_mov_b64 exec, 1
    ds_write_b32 v202, v50 offset:4128
    s_mov_b64 exec, -1
    v_add_f32 v52, v52, v31
    v_and_b32 v5, 1, v1
    v_cmp_eq_u32 vcc, 0, v5
    s_mov_b32 s79, 0
XP19:
    ds_read_b32 v4, v205 offset:4128
    ds_read_b128 v[68:71], v203 offset:0
    ds_read_b128 v[72:75], v203 offset:1024
    ds_read_b128 v[76:79], v203 offset:2048
    ds_read_b128 v[80:83], v203 offset:3072
    s_add_u32 s79, s79, 1
    s_waitcnt lgkmcnt(4)
    v_readfirstlane_b32 s76, v4
    s_nop 0
    s_cmp_lg_u32 s76, 0
    s_cbranch_scc1 XQ20
    s_cmp_gt_u32 s79, 2097152
    s_cbranch_scc0 XP19
XQ20:
    s_waitcnt lgkmcnt(3)
    v_add_f32 v52, v52, v68
    v_add_f32 v53, v53, v69
    v_add_f32 v54, v54, v70
    v_add_f32 v55, v55, v71
    s_waitcnt lgkmcnt(2)
    v_add_f32 v56, v56, v72
    v_add_f32 v57, v57, v73
    v_add_f32 v58, v58, v74
    v_add_f32 v59, v59, v75
    s_waitcnt lgkmcnt(1)
    v_add_f32 v60, v60, v76
    v_add_f32 v61, v61, v77
    v_add_f32 v62, v62, v78
    v_add_f32 v63, v63, v79
    s_waitcnt lgkmcnt(0)
    v_add_f32 v64, v64, v80
    v_add_f32 v65, v65, v81
    v_add_f32 v66, v66, v82
    v_add_f32 v67, v67, v83
    v_cndmask_b32 v84, v65, v64, vcc
    v_cndmask_b32 v85, v67, v66, vcc
    s_cmp_eq_u32 s60, 0
    s_cbranch_scc0 LS_T1
    v_cvt_pk_bf16_f32 v68, v59, v58
    v_cvt_pk_bf16_f32 v69, v57, v56
    v_cvt_pk_bf16_f32 v70, v55, v54
    v_cvt_pk_bf16_f32 v71, v53, v52
    ds_write_b128 v204, v[68:71] offset:3072
    v_cvt_pk_bf16_f32 v72, v63, v63
    v_cvt_pk_bf16_f32 v73, v62, v62
    v_cvt_pk_bf16_f32 v74, v62, v61
    v_cvt_pk_bf16_f32 v75, v61, v61
    ds_write_b128 v204, v[72:75] offset:2048
    v_cvt_pk_bf16_f32 v76, v65, v65
    v_cvt_pk_bf16_f32 v77, v65, v84
    v_cvt_pk_bf16_f32 v78, v64, v64
    v_cvt_pk_bf16_f32 v79, v64, v64
    ds_write_b128 v204, v[76:79] offset:1024
    v_cvt_pk_bf16_f32 v80, v67, v67
    v_cvt_pk_bf16_f32 v81, v67, v85
    v_cvt_pk_bf16_f32 v82, v66, v66
    v_cvt_pk_bf16_f32 v83, v66, v66
    ds_write_b128 v204, v[80:83] offset:0
    s_branch LS_T2
LS_T1:
    s_nop 0
    v_cvt_pk_bf16_f32 v68, v60, v59
    v_cvt_pk_bf16_f32 v69, v58, v57
    v_cvt_pk_bf16_f32 v70, v56, v55
    v_cvt_pk_bf16_f32 v71, v54, v53
    ds_write_b128 v204, v[68:71] offset:3072
    v_cvt_pk_bf16_f32 v72, v63, v63
    v_cvt_pk_bf16_f32 v73, v63, v62
    v_cvt_pk_bf16_f32 v74, v62, v62
    v_cvt_pk_bf16_f32 v75, v61, v61
    ds_write_b128 v204, v[72:75] offset:2048
    v_cvt_pk_bf16_f32 v76, v65, v65
    v_cvt_pk_bf16_f32 v77, v65, v65
    v_cvt_pk_bf16_f32 v78, v84, v64
    v_cvt_pk_bf16_f32 v79, v64, v64
    ds_write_b128 v204, v[76:79] offset:1024
    v_cvt_pk_bf16_f32 v80, v67, v67
    v_cvt_pk_bf16_f32 v81, v67, v67
    v_cvt_pk_bf16_f32 v82, v85, v66
    v_cvt_pk_bf16_f32 v83, v66, v66
    ds_write_b128 v204, v[80:83] offset:0
    v_cvt_pk_bf16_f32 v8, v52, 0
    s_mov_b64 exec, 1
    ds_write_b32 v203, v8 offset:4096
    s_mov_b64 exec, -1
LS_T2:
    s_setprio 0
    s_cmp_eq_u32 s37, 0
    s_cbranch_scc1 NX11
    s_waitcnt vmcnt(0)
    v_cmp_ne_u32 vcc, s21, v183
    s_nop 0
    s_cbranch_vccz OK21
    s_mov_b32 s79, 0
P22:
    buffer_load_dword v183, v184, s[52:55], s20 offen sc1
    s_add_u32 s79, s79, 1
    s_waitcnt vmcnt(0)
    v_cmp_ne_u32 vcc, s21, v183
    s_nop 0
    s_cbranch_vccz PE23
    s_sleep 4
    s_cmp_gt_u32 s79, 32768
    s_cbranch_scc0 P22
PE23:
OK21:
    s_mov_b32 m0, s27
    s_nop 0
    buffer_load_dwordx4 v181, s[52:55], s26 offen sc1 lds
    buffer_load_dwordx4 v181, s[52:55], s26 offen offset:1024 sc1 lds
NX11:
    s_waitcnt vmcnt(0)
    s_setprio 2
    s_cmp_eq_u32 s37, 0
    s_cbranch_scc0 NB24
    s_waitcnt lgkmcnt(0)
    s_barrier
    s_branch XQ26
NB24:
    s_lshr_b32 s76, s34, 2
    s_mul_i32 s76, s76, 16640
    s_add_u32 s76, s76, 53292
    v_mov_b32 v5, s76
    v_mov_b32 v4, 1
    s_mov_b64 exec, 1
    ds_add_u32 v5, v4
    s_mov_b64 exec, -1
    s_mov_b32 s79, 0
XP25:
    ds_read_b32 v4, v5
    s_add_u32 s79, s79, 1
    s_waitcnt lgkmcnt(0)
    v_readfirstlane_b32 s76, v4
    s_nop 0
    s_cmp_eq_u32 s76, 4
    s_cbranch_scc1 XT27
    s_sleep 1
    s_cmp_gt_u32 s79, 2097152
    s_cbranch_scc0 XP25
XT27:
XQ26:
    ds_read2_b32 v[48:49], v176 offset0:176 offset1:177
    ds_read2_b32 v[50:51], v176 offset0:178 offset1:179
    ds_read_b128 v[80:83], v186 offset:0
    ds_read2_b32 v[52:53], v176 offset0:48 offset1:49
    ds_read2_b32 v[54:55], v176 offset0:50 offset1:51
    ds_read_b128 v[84:87], v186 offset:1024
    ds_read2_b32 v[56:57], v177 offset0:176 offset1:177
    ds_read2_b32 v[58:59], v177 offset0:178 offset1:179
    ds_read_b128 v[88:91], v186 offset:2048
    ds_read2_b32 v[60:61], v177 offset0:48 offset1:49
    ds_read2_b32 v[62:63], v177 offset0:50 offset1:51
    ds_read_b128 v[92:95], v186 offset:3072
    s_waitcnt lgkmcnt(9)
    v_mfma_f32_16x16x32_bf16 v[16:19], v[48:51], v[80:83], 0
    ds_read2_b32 v[64:65], v178 offset0:176 offset1:177
    s_waitcnt lgkmcnt(7)
    v_mfma_f32_16x16x32_bf16 v[20:23], v[48:51], v[84:87], 0
    ds_read2_b32 v[66:67], v178 offset0:178 offset1:179
    v_mfma_f32_16x16x32_bf16 v[20:23], v[52:55], v[80:83], v[20:23]
    ds_read_b128 v[96:99], v186 offset:4096
    v_mfma_f32_16x16x32_bf16 v[24:27], v[52:55], v[84:87], 0
    ds_read2_b32 v[68:69], v178 offset0:48 offset1:49
    s_waitcnt lgkmcnt(7)
    v_mfma_f32_16x16x32_bf16 v[24:27], v[48:51], v[88:91], v[24:27]
    ds_read2_b32 v[70:71], v178 offset0:50 offset1:51
    v_mfma_f32_16x16x32_bf16 v[28:31], v[52:55], v[88:91], 0
    ds_read_b128 v[100:103], v186 offset:5120
    v_mfma_f32_16x16x32_bf16 v[24:27], v[56:59], v[80:83], v[24:27]
    ds_read2_b32 v[72:73], v179 offset0:176 offset1:177
    v_mfma_f32_16x16x32_bf16 v[28:31], v[56:59], v[84:87], v[28:31]
    ds_read2_b32 v[74:75], v179 offset0:178 offset1:179
    v_mfma_f32_16x16x32_bf16 v[32:35], v[56:59], v[88:91], 0
    ds_read_b128 v[104:107], v186 offset:6144
    s_waitcnt lgkmcnt(9)
    v_mfma_f32_16x16x32_bf16 v[28:31], v[48:51], v[92:95], v[28:31]
    ds_read2_b32 v[76:77], v179 offset0:48 offset1:49
    v_mfma_f32_16x16x32_bf16 v[32:35], v[52:55], v[92:95], v[32:35]
    ds_read2_b32 v[78:79], v179 offset0:50 offset1:51
    v_mfma_f32_16x16x32_bf16 v[36:39], v[56:59], v[92:95], 0
    ds_read_b128 v[108:111], v186 offset:7168
    v_mfma_f32_16x16x32_bf16 v[28:31], v[60:63], v[80:83], v[28:31]
    ds_read2_b32 v[112:113], v176 offset0:160 offset1:161
    v_mfma_f32_16x16x32_bf16 v[32:35], v[60:63], v[84:87], v[32:35]
    ds_read2_b32 v[114:115], v176 offset0:162 offset1:163
    v_mfma_f32_16x16x32_bf16 v[36:39], v[60:63], v[88:91], v[36:39]
    ds_read_b128 v[144:147], v187 offset:0
    v_mfma_f32_16x16x32_bf16 v[40:43], v[60:63], v[92:95], 0
    ds_read2_b32 v[116:117], v176 offset0:32 offset1:33
    s_waitcnt lgkmcnt(13)
    s_nop 0
    v_mfma_f32_16x16x32_bf16 v[32:35], v[48:51], v[96:99], v[32:35]
    ds_read2_b32 v[118:119], v176 offset0:34 offset1:35
    v_mfma_f32_16x16x32_bf16 v[36:39], v[52:55], v[96:99], v[36:39]
    ds_read_b128 v[148:151], v187 offset:1024
    v_mfma_f32_16x16x32_bf16 v[40:43], v[56:59], v[96:99], v[40:43]
    ds_read2_b32 v[120:121], v177 offset0:160 offset1:161
    v_mfma_f32_16x16x32_bf16 v[44:47], v[60:63], v[96:99], 0
    ds_read2_b32 v[122:123], v177 offset0:162 offset1:163
    v_mfma_f32_16x16x32_bf16 v[32:35], v[64:67], v[80:83], v[32:35]
    ds_read_b128 v[152:155], v187 offset:2048
    v_mfma_f32_16x16x32_bf16 v[36:39], v[64:67], v[84:87], v[36:39]
    ds_read2_b32 v[124:125], v177 offset0:32 offset1:33
    v_mfma_f32_16x16x32_bf16 v[40:43], v[64:67], v[88:91], v[40:43]
    ds_read2_b32 v[126:127], v177 offset0:34 offset1:35
    v_mfma_f32_16x16x32_bf16 v[44:47], v[64:67], v[92:95], v[44:47]
    ds_read_b128 v[156:159], v187 offset:3072
    s_waitcnt lgkmcnt(15)
    v_mfma_f32_16x16x32_bf16 v[36:39], v[48:51], v[100:103], v[36:39]
    ds_read2_b32 v[128:129], v178 offset0:160 offset1:161
    v_mfma_f32_16x16x32_bf16 v[40:43], v[52:55], v[100:103], v[40:43]
    ds_read2_b32 v[130:131], v178 offset0:162 offset1:163
    v_mfma_f32_16x16x32_bf16 v[44:47], v[56:59], v[100:103], v[44:47]
    ds_read_b128 v[160:163], v187 offset:4096
    v_mfma_f32_16x16x32_bf16 v[36:39], v[68:71], v[80:83], v[36:39]
    ds_read2_b32 v[132:133], v178 offset0:32 offset1:33
PADS2:
    s_cbranch_execz WR3
    v_mfma_f32_16x16x32_bf16 v[40:43], v[68:71], v[84:87], v[40:43]
    ds_read2_b32 v[134:135], v178 offset0:34 offset1:35
    v_mfma_f32_16x16x32_bf16 v[44:47], v[68:71], v[88:91], v[44:47]
    ds_read_b128 v[164:167], v187 offset:5120
    s_waitcnt lgkmcnt(15)
    v_mfma_f32_16x16x32_bf16 v[40:43], v[48:51], v[104:107], v[40:43]
    ds_read2_b32 v[136:137], v179 offset0:160 offset1:161
    v_mfma_f32_16x16x32_bf16 v[44:47], v[52:55], v[104:107], v[44:47]
    ds_read2_b32 v[138:139], v179 offset0:162 offset1:163
    v_mfma_f32_16x16x32_bf16 v[40:43], v[72:75], v[80:83], v[40:43]
    ds_read_b128 v[168:171], v187 offset:6144
    v_mfma_f32_16x16x32_bf16 v[44:47], v[72:75], v[84:87], v[44:47]
    ds_read2_b32 v[140:141], v179 offset0:32 offset1:33
    s_waitcnt lgkmcnt(15)
    v_mfma_f32_16x16x32_bf16 v[44:47], v[48:51], v[108:111], v[44:47]
    ds_read2_b32 v[142:143], v179 offset0:34 offset1:35
    v_mfma_f32_16x16x32_bf16 v[44:47], v[76:79], v[80:83], v[44:47]
    ds_read_b128 v[172:175], v187 offset:7168
    s_waitcnt lgkmcnt(0)
    s_nop 0
    v_mfma_f32_16x16x32_bf16 v[16:19], v[112:115], v[144:147], v[16:19]
    ds_read2_b32 v[48:49], v176 offset0:144 offset1:145
    v_mfma_f32_16x16x32_bf16 v[20:23], v[112:115], v[148:151], v[20:23]
    ds_read2_b32 v[50:51], v176 offset0:146 offset1:147
    v_mfma_f32_16x16x32_bf16 v[20:23], v[116:119], v[144:147], v[20:23]
    ds_read_b128 v[80:83], v188 offset:0
    v_mfma_f32_16x16x32_bf16 v[24:27], v[112:115], v[152:155], v[24:27]
    ds_read2_b32 v[52:53], v176 offset0:16 offset1:17
    v_mfma_f32_16x16x32_bf16 v[24:27], v[116:119], v[148:151], v[24:27]
    ds_read2_b32 v[54:55], v176 offset0:18 offset1:19
    v_mfma_f32_16x16x32_bf16 v[24:27], v[120:123], v[144:147], v[24:27]
    ds_read_b128 v[84:87], v188 offset:1024
    v_mfma_f32_16x16x32_bf16 v[28:31], v[112:115], v[156:159], v[28:31]
    ds_read2_b32 v[56:57], v177 offset0:144 offset1:145
    v_mfma_f32_16x16x32_bf16 v[28:31], v[116:119], v[152:155], v[28:31]
    ds_read2_b32 v[58:59], v177 offset0:146 offset1:147
    v_mfma_f32_16x16x32_bf16 v[28:31], v[120:123], v[148:151], v[28:31]
    ds_read_b128 v[88:91], v188 offset:2048
    v_mfma_f32_16x16x32_bf16 v[28:31], v[124:127], v[144:147], v[28:31]
    ds_read2_b32 v[60:61], v177 offset0:16 offset1:17
    v_mfma_f32_16x16x32_bf16 v[32:35], v[112:115], v[160:163], v[32:35]
    ds_read2_b32 v[62:63], v177 offset0:18 offset1:19
    v_mfma_f32_16x16x32_bf16 v[32:35], v[116:119], v[156:159], v[32:35]
    ds_read_b128 v[92:95], v188 offset:3072
    v_mfma_f32_16x16x32_bf16 v[32:35], v[120:123], v[152:155], v[32:35]
    ds_read2_b32 v[64:65], v178 offset0:144 offset1:145
    v_mfma_f32_16x16x32_bf16 v[32:35], v[124:127], v[148:151], v[32:35]
    ds_read2_b32 v[66:67], v178 offset0:146 offset1:147
    v_mfma_f32_16x16x32_bf16 v[32:35], v[128:131], v[144:147], v[32:35]
    ds_read_b128 v[96:99], v188 offset:4096
    v_mfma_f32_16x16x32_bf16 v[36:39], v[112:115], v[164:167], v[36:39]
    ds_read2_b32 v[68:69], v178 offset0:16 offset1:17
    v_mfma_f32_16x16x32_bf16 v[36:39], v[116:119], v[160:163], v[36:39]
    ds_read2_b32 v[70:71], v178 offset0:18 offset1:19
    v_mfma_f32_16x16x32_bf16 v[36:39], v[120:123], v[156:159], v[36:39]
    ds_read_b128 v[100:103], v188 offset:5120
    v_mfma_f32_16x16x32_bf16 v[36:39], v[124:127], v[152:155], v[36:39]
    ds_read2_b32 v[72:73], v179 offset0:144 offset1:145
    v_mfma_f32_16x16x32_bf16 v[36:39], v[128:131], v[148:151], v[36:39]
    ds_read2_b32 v[74:75], v179 offset0:146 offset1:147
    v_mfma_f32_16x16x32_bf16 v[36:39], v[132:135], v[144:147], v[36:39]
    ds_read_b128 v[104:107], v188 offset:6144
    v_mfma_f32_16x16x32_bf16 v[40:43], v[112:115], v[168:171], v[40:43]
    ds_read2_b32 v[76:77], v179 offset0:16 offset1:17
    v_mfma_f32_16x16x32_bf16 v[40:43], v[116:119], v[164:167], v[40:43]
    ds_read2_b32 v[78:79], v179 offset0:18 offset1:19
    v_mfma_f32_16x16x32_bf16 v[40:43], v[120:123], v[160:163], v[40:43]
    ds_read_b128 v[108:111], v188 offset:7168
    v_mfma_f32_16x16x32_bf16 v[40:43], v[124:127], v[156:159], v[40:43]
    v_mfma_f32_16x16x32_bf16 v[40:43], v[128:131], v[152:155], v[40:43]
    v_mfma_f32_16x16x32_bf16 v[40:43], v[132:135], v[148:151], v[40:43]
    v_mfma_f32_16x16x32_bf16 v[40:43], v[136:139], v[144:147], v[40:43]
    v_mfma_f32_16x16x32_bf16 v[44:47], v[112:115], v[172:175], v[44:47]
    v_mfma_f32_16x16x32_bf16 v[44:47], v[116:119], v[168:171], v[44:47]
    v_mfma_f32_16x16x32_bf16 v[44:47], v[120:123], v[164:167], v[44:47]
    v_mfma_f32_16x16x32_bf16 v[44:47], v[124:127], v[160:163], v[44:47]
    v_mfma_f32_16x16x32_bf16 v[44:47], v[128:131], v[156:159], v[44:47]
    v_mfma_f32_16x16x32_bf16 v[44:47], v[132:135], v[152:155], v[44:47]
    v_mfma_f32_16x16x32_bf16 v[44:47], v[136:139], v[148:151], v[44:47]
    v_mfma_f32_16x16x32_bf16 v[44:47], v[140:143], v[144:147], v[44:47]
    s_waitcnt lgkmcnt(0)
    s_nop 0
    v_mfma_f32_16x16x32_bf16 v[16:19], v[48:51], v[80:83], v[16:19]
    ds_read2_b32 v[112:113], v176 offset0:128 offset1:129
    v_mfma_f32_16x16x32_bf16 v[20:23], v[48:51], v[84:87], v[20:23]
    ds_read2_b32 v[114:115], v176 offset0:130 offset1:131
    v_mfma_f32_16x16x32_bf16 v[20:23], v[52:55], v[80:83], v[20:23]
    ds_read_b128 v[144:147], v189 offset:0
    v_mfma_f32_16x16x32_bf16 v[24:27], v[48:51], v[88:91], v[24:27]
    ds_read2_b32 v[116:117], v176 offset0:0 offset1:1
    v_mfma_f32_16x16x32_bf16 v[24:27], v[52:55], v[84:87], v[24:27]
    ds_read2_b32 v[118:119], v176 offset0:2 offset1:3
    v_mfma_f32_16x16x32_bf16 v[24:27], v[56:59], v[80:83], v[24:27]
    ds_read_b128 v[148:151], v189 offset:1024
    v_mfma_f32_16x16x32_bf16 v[28:31], v[48:51], v[92:95], v[28:31]
    ds_read2_b32 v[120:121], v177 offset0:128 offset1:129
    v_mfma_f32_16x16x32_bf16 v[28:31], v[52:55], v[88:91], v[28:31]
    ds_read2_b32 v[122:123], v177 offset0:130 offset1:131
    v_mfma_f32_16x16x32_bf16 v[28:31], v[56:59], v[84:87], v[28:31]
    ds_read_b128 v[152:155], v189 offset:2048
    v_mfma_f32_16x16x32_bf16 v[28:31], v[60:63], v[80:83], v[28:31]
    ds_read2_b32 v[124:125], v177 offset0:0 offset1:1
    v_mfma_f32_16x16x32_bf16 v[32:35], v[48:51], v[96:99], v[32:35]
    ds_read2_b32 v[126:127], v177 offset0:2 offset1:3
    v_mfma_f32_16x16x32_bf16 v[32:35], v[52:55], v[92:95], v[32:35]
    ds_read_b128 v[156:159], v189 offset:3072
    v_mfma_f32_16x16x32_bf16 v[32:35], v[56:59], v[88:91], v[32:35]
    ds_read2_b32 v[128:129], v178 offset0:128 offset1:129
    v_mfma_f32_16x16x32_bf16 v[32:35], v[60:63], v[84:87], v[32:35]
    ds_read2_b32 v[130:131], v178 offset0:130 offset1:131
    v_mfma_f32_16x16x32_bf16 v[32:35], v[64:67], v[80:83], v[32:35]
    ds_read_b128 v[160:163], v189 offset:4096
    v_mfma_f32_16x16x32_bf16 v[36:39], v[48:51], v[100:103], v[36:39]
    ds_read2_b32 v[132:133], v178 offset0:0 offset1:1
    v_mfma_f32_16x16x32_bf16 v[36:39], v[52:55], v[96:99], v[36:39]
    ds_read2_b32 v[134:135], v178 offset0:2 offset1:3
    v_mfma_f32_16x16x32_bf16 v[36:39], v[56:59], v[92:95], v[36:39]
    ds_read_b128 v[164:167], v189 offset:5120
    v_mfma_f32_16x16x32_bf16 v[36:39], v[60:63], v[88:91], v[36:39]
    ds_read2_b32 v[136:137], v179 offset0:128 offset1:129
    v_mfma_f32_16x16x32_bf16 v[36:39], v[64:67], v[84:87], v[36:39]
    ds_read2_b32 v[138:139], v179 offset0:130 offset1:131
    v_mfma_f32_16x16x32_bf16 v[36:39], v[68:71], v[80:83], v[36:39]
    ds_read_b128 v[168:171], v189 offset:6144
    v_mfma_f32_16x16x32_bf16 v[40:43], v[48:51], v[104:107], v[40:43]
    ds_read2_b32 v[140:141], v179 offset0:0 offset1:1
    v_mfma_f32_16x16x32_bf16 v[40:43], v[52:55], v[100:103], v[40:43]
    ds_read2_b32 v[142:143], v179 offset0:2 offset1:3
    v_mfma_f32_16x16x32_bf16 v[40:43], v[56:59], v[96:99], v[40:43]
    ds_read_b128 v[172:175], v189 offset:7168
    v_mfma_f32_16x16x32_bf16 v[40:43], v[60:63], v[92:95], v[40:43]
    v_mfma_f32_16x16x32_bf16 v[40:43], v[64:67], v[88:91], v[40:43]
    v_mfma_f32_16x16x32_bf16 v[40:43], v[68:71], v[84:87], v[40:43]
    v_mfma_f32_16x16x32_bf16 v[40:43], v[72:75], v[80:83], v[40:43]
    v_mfma_f32_16x16x32_bf16 v[44:47], v[48:51], v[108:111], v[44:47]
    v_mfma_f32_16x16x32_bf16 v[44:47], v[52:55], v[104:107], v[44:47]
    v_mfma_f32_16x16x32_bf16 v[44:47], v[56:59], v[100:103], v[44:47]
    v_mfma_f32_16x16x32_bf16 v[44:47], v[60:63], v[96:99], v[44:47]
    v_mfma_f32_16x16x32_bf16 v[44:47], v[64:67], v[92:95], v[44:47]
    v_mfma_f32_16x16x32_bf16 v[44:47], v[68:71], v[88:91], v[44:47]
    v_mfma_f32_16x16x32_bf16 v[44:47], v[72:75], v[84:87], v[44:47]
    v_mfma_f32_16x16x32_bf16 v[44:47], v[76:79], v[80:83], v[44:47]
    s_waitcnt lgkmcnt(0)
    s_mov_b64 exec, 1
    ds_write_b32 v202, v202 offset:4132
    s_mov_b64 exec, -1
    s_nop 3
    v_mfma_f32_16x16x32_bf16 v[16:19], v[112:115], v[144:147], v[16:19]
    v_mfma_f32_16x16x32_bf16 v[20:23], v[112:115], v[148:151], v[20:23]
    v_mfma_f32_16x16x32_bf16 v[20:23], v[116:119], v[144:147], v[20:23]
    v_mfma_f32_16x16x32_bf16 v[24:27], v[112:115], v[152:155], v[24:27]
    v_mfma_f32_16x16x32_bf16 v[24:27], v[116:119], v[148:151], v[24:27]
    v_mfma_f32_16x16x32_bf16 v[24:27], v[120:123], v[144:147], v[24:27]
    v_mfma_f32_16x16x32_bf16 v[28:31], v[112:115], v[156:159], v[28:31]
    v_mfma_f32_16x16x32_bf16 v[28:31], v[116:119], v[152:155], v[28:31]
    v_mfma_f32_16x16x32_bf16 v[28:31], v[120:123], v[148:151], v[28:31]
    v_mfma_f32_16x16x32_bf16 v[28:31], v[124:127], v[144:147], v[28:31]
    v_mfma_f32_16x16x32_bf16 v[32:35], v[112:115], v[160:163], v[32:35]
    v_mfma_f32_16x16x32_bf16 v[32:35], v[116:119], v[156:159], v[32:35]
    v_mfma_f32_16x16x32_bf16 v[32:35], v[120:123], v[152:155], v[32:35]
    v_mfma_f32_16x16x32_bf16 v[32:35], v[124:127], v[148:151], v[32:35]
    v_mfma_f32_16x16x32_bf16 v[32:35], v[128:131], v[144:147], v[32:35]
    v_mfma_f32_16x16x32_bf16 v[36:39], v[112:115], v[164:167], v[36:39]
    v_mfma_f32_16x16x32_bf16 v[36:39], v[116:119], v[160:163], v[36:39]
    v_mfma_f32_16x16x32_bf16 v[36:39], v[120:123], v[156:159], v[36:39]
    v_mfma_f32_16x16x32_bf16 v[36:39], v[124:127], v[152:155], v[36:39]
    v_mfma_f32_16x16x32_bf16 v[36:39], v[128:131], v[148:151], v[36:39]
    v_mfma_f32_16x16x32_bf16 v[36:39], v[132:135], v[144:147], v[36:39]
    v_mfma_f32_16x16x32_bf16 v[40:43], v[112:115], v[168:171], v[40:43]
    v_mfma_f32_16x16x32_bf16 v[40:43], v[116:119], v[164:167], v[40:43]
    v_mfma_f32_16x16x32_bf16 v[40:43], v[120:123], v[160:163], v[40:43]
    v_mfma_f32_16x16x32_bf16 v[40:43], v[124:127], v[156:159], v[40:43]
    v_mfma_f32_16x16x32_bf16 v[40:43], v[128:131], v[152:155], v[40:43]
    v_mfma_f32_16x16x32_bf16 v[40:43], v[132:135], v[148:151], v[40:43]
    v_mfma_f32_16x16x32_bf16 v[40:43], v[136:139], v[144:147], v[40:43]
    v_mfma_f32_16x16x32_bf16 v[44:47], v[112:115], v[172:175], v[44:47]
    v_mfma_f32_16x16x32_bf16 v[44:47], v[116:119], v[168:171], v[44:47]
    v_mfma_f32_16x16x32_bf16 v[44:47], v[120:123], v[164:167], v[44:47]
    v_mfma_f32_16x16x32_bf16 v[44:47], v[124:127], v[160:163], v[44:47]
    v_mfma_f32_16x16x32_bf16 v[44:47], v[128:131], v[156:159], v[44:47]
    v_mfma_f32_16x16x32_bf16 v[44:47], v[132:135], v[152:155], v[44:47]
    v_mfma_f32_16x16x32_bf16 v[44:47], v[136:139], v[148:151], v[44:47]
    v_mfma_f32_16x16x32_bf16 v[44:47], v[140:143], v[144:147], v[44:47]
    s_mov_b32 s79, 0
XP28:
    ds_read_b32 v4, v205 offset:4132
    s_add_u32 s79, s79, 1
    s_waitcnt lgkmcnt(0)
    v_readfirstlane_b32 s76, v4
    s_nop 0
    s_cmp_lg_u32 s76, 0
    s_cbranch_scc1 XQ29
    s_cmp_gt_u32 s79, 2097152
    s_cbranch_scc0 XP28
XQ29:
    s_nop 3
    s_cmp_eq_u32 s60, 0
    s_cbranch_scc0 LS_R1
    ds_write_b128 v202, v[32:35] offset:0
    ds_write_b128 v202, v[36:39] offset:1024
    ds_write_b128 v202, v[40:43] offset:2048
    ds_write_b128 v202, v[44:47] offset:3072
    s_mov_b64 exec, 1
    ds_write_b32 v202, v202 offset:4136
    s_mov_b64 exec, -1
    s_branch LS_R2
LS_R1:
    ds_write_b128 v202, v[16:19] offset:0
    ds_write_b128 v202, v[20:23] offset:1024
    ds_write_b128 v202, v[24:27] offset:2048
    ds_write_b128 v202, v[28:31] offset:3072
    s_mov_b64 exec, 1
    ds_write_b32 v202, v202 offset:4136
    s_mov_b64 exec, -1
    v_mov_b32 v16, v32
    v_mov_b32 v17, v33
    v_mov_b32 v18, v34
    v_mov_b32 v19, v35
    v_mov_b32 v20, v36
    v_mov_b32 v21, v37
    v_mov_b32 v22, v38
    v_mov_b32 v23, v39
    v_mov_b32 v24, v40
    v_mov_b32 v25, v41
    v_mov_b32 v26, v42
    v_mov_b32 v27, v43
    v_mov_b32 v28, v44
    v_mov_b32 v29, v45
    v_mov_b32 v30, v46
    v_mov_b32 v31, v47
LS_R2:
    s_mov_b32 s79, 0
XP30:
    ds_read_b32 v4, v205 offset:4136
    ds_read_b128 v[48:51], v203 offset:0
    ds_read_b128 v[52:55], v203 offset:1024
    ds_read_b128 v[56:59], v203 offset:2048
    ds_read_b128 v[60:63], v203 offset:3072
    s_add_u32 s79, s79, 1
    s_waitcnt lgkmcnt(4)
    v_readfirstlane_b32 s76, v4
    s_nop 0
    s_cmp_lg_u32 s76, 0
    s_cbranch_scc1 XQ31
    s_cmp_gt_u32 s79, 2097152
    s_cbranch_scc0 XP30
XQ31:
    s_lshl_b32 s76, s61, 12
    s_lshl_b32 s77, s60, 11
    s_add_u32 s76, s76, s77
    s_add_u32 s76, s76, 10485760
    v_lshlrev_b32 v4, 4, v1
    s_waitcnt lgkmcnt(2)
    v_add_f32 v16, v16, v48
    v_add_f32 v17, v17, v49
    v_add_f32 v18, v18, v50
    v_add_f32 v19, v19, v51
    v_add_f32 v20, v20, v52
    v_add_f32 v21, v21, v53
    v_add_f32 v22, v22, v54
    v_add_f32_e64 v23, v23, v55
    v_cvt_pk_bf16_f32 v64, v16, v17
    v_cvt_pk_bf16_f32 v65, v18, v19
    v_cvt_pk_bf16_f32 v66, v20, v21
    v_cvt_pk_bf16_f32 v67, v22, v23
    s_nop 0
    v_permlane16_swap_b32 v64, v66
    v_permlane16_swap_b32 v65, v67
    buffer_store_dwordx4 v[64:67], v4, s[52:55], s76 offen offset:0 sc1
    s_waitcnt lgkmcnt(0)
    v_add_f32 v24, v24, v56
    v_add_f32 v25, v25, v57
    v_add_f32 v26, v26, v58
    v_add_f32 v27, v27, v59
    v_add_f32 v28, v28, v60
    v_add_f32 v29, v29, v61
    v_add_f32 v30, v30, v62
    v_add_f32 v31, v31, v63
    v_cvt_pk_bf16_f32 v68, v24, v25
    v_cvt_pk_bf16_f32 v69, v26, v27
    v_cvt_pk_bf16_f32 v70, v28, v29
    v_cvt_pk_bf16_f32 v71, v30, v31
    s_nop 0
    v_permlane16_swap_b32 v68, v70
    v_permlane16_swap_b32 v69, v71
    buffer_store_dwordx4 v[68:71], v4, s[52:55], s76 offen offset:1024 sc1
    s_setprio 0
    s_mul_i32 s76, s60, 640
    s_add_u32 s76, s76, s61
    s_lshl_b32 s76, s76, 7
    s_add_u32 s76, s76, 13893632
    v_mov_b32 v8, s21
    v_mov_b32 v9, s21
    v_mov_b32 v10, s21
    v_mov_b32 v11, s21
    v_lshlrev_b32 v12, 4, v1
    s_waitcnt vmcnt(0)
    s_mov_b64 exec, 0xff
    buffer_store_dwordx4 v[8:11], v12, s[52:55], s76 offen sc1
    s_mov_b64 exec, -1
    s_lshl_b32 s76, s34, 8
    s_add_u32 s76, s76, s2
    s_cmp_eq_u32 s76, 192
    s_cbranch_scc0 EP32
    v_lshrrev_b32 v2, 2, v1
    v_mul_u32_u24 v2, 6144, v2
    v_and_b32 v3, 3, v1
    v_lshl_add_u32 v2, v3, 8, v2
    s_mov_b32 s20, 13697024
    v_lshlrev_b32 v6, 7, v1
    s_mov_b32 s18, 13664256
    s_mov_b32 s79, 0
P33:
    buffer_load_dword v3, v6, s[52:55], s18 offen sc1
    s_add_u32 s79, s79, 1
    s_waitcnt vmcnt(0)
    v_cmp_ne_u32 vcc, s21, v3
    s_nop 0
    s_cbranch_vccz PE34
    s_sleep 4
    s_cmp_gt_u32 s79, 32768
    s_cbranch_scc0 P33
PE34:
    s_mov_b32 s79, 0
P35:
    buffer_load_dword v3, v2, s[52:55], s20 offen offset:0 sc1
    buffer_load_dword v4, v2, s[52:55], s20 offen offset:1024 sc1
    buffer_load_dword v5, v2, s[52:55], s20 offen offset:2048 sc1
    s_add_u32 s79, s79, 1
    s_waitcnt vmcnt(0)
    v_cmp_ne_u32 vcc, s21, v3
    v_cmp_ne_u32 s[76:77], s21, v4
    v_cmp_ne_u32 s[16:17], s21, v5
    s_or_b64 vcc, vcc, s[76:77]
    s_or_b64 vcc, vcc, s[16:17]
    s_cbranch_vccz PE36
    s_sleep 4
    s_cmp_gt_u32 s79, 32768
    s_cbranch_scc0 P35
PE36:
    s_mov_b32 s20, 13680640
    s_mov_b64 exec, 1
    buffer_store_dword v8, off, s[52:55], s20 sc1
    s_branch L_FIN
EP32:
    s_cmp_lt_u32 s36, 20
    s_cbranch_scc0 L_FIN
    s_mul_i32 s20, s62, 6144
    s_mul_i32 s77, s3, 1536
    s_add_u32 s20, s20, s77
    s_add_u32 s20, s20, 13795328
    s_add_u32 s22, s32, s20
    s_addc_u32 s23, s33, 0
    s_mov_b32 s79, 0
SP37:
    s_load_dword s64, s[22:23], 0 glc
    s_load_dword s65, s[22:23], 128 glc
    s_load_dword s66, s[22:23], 256 glc
    s_load_dword s67, s[22:23], 384 glc
    s_load_dword s68, s[22:23], 512 glc
    s_load_dword s69, s[22:23], 640 glc
    s_load_dword s70, s[22:23], 768 glc
    s_load_dword s71, s[22:23], 896 glc
    s_load_dword s72, s[22:23], 1024 glc
    s_load_dword s73, s[22:23], 1152 glc
    s_load_dword s74, s[22:23], 1280 glc
    s_load_dword s75, s[22:23], 1408 glc
    s_add_u32 s79, s79, 1
    s_waitcnt lgkmcnt(0)
    s_xor_b32 s76, s64, s21
    s_xor_b32 s77, s65, s21
    s_or_b32 s76, s76, s77
    s_xor_b32 s77, s66, s21
    s_or_b32 s76, s76, s77
    s_xor_b32 s77, s67, s21
    s_or_b32 s76, s76, s77
    s_xor_b32 s77, s68, s21
    s_or_b32 s76, s76, s77
    s_xor_b32 s77, s69, s21
    s_or_b32 s76, s76, s77
    s_xor_b32 s77, s70, s21
    s_or_b32 s76, s76, s77
    s_xor_b32 s77, s71, s21
    s_or_b32 s76, s76, s77
    s_xor_b32 s77, s72, s21
    s_or_b32 s76, s76, s77
    s_xor_b32 s77, s73, s21
    s_or_b32 s76, s76, s77
    s_xor_b32 s77, s74, s21
    s_or_b32 s76, s76, s77
    s_xor_b32 s77, s75, s21
    s_or_b32 s76, s76, s77
    s_cbranch_scc0 SE38
    s_sleep 4
    s_cmp_gt_u32 s79, 32768
    s_cbranch_scc0 SP37
SE38:
    s_barrier
    s_lshl_b32 s60, s63, 6
    s_lshl_b32 s76, s3, 4
    s_add_u32 s60, s60, s76
    s_lshr_b32 s76, s35, 2
    s_mul_i32 s76, s76, 640
    s_add_u32 s76, s76, s60
    s_lshl_b32 s76, s76, 7
    s_add_u32 s61, s76, 13893632
    v_and_b32 v4, 15, v1
    v_lshrrev_b32 v7, 4, v1
    v_lshlrev_b32 v8, 1, v7
    v_xor_b32 v8, v8, v4
    v_lshrrev_b32 v9, 1, v8
    v_lshlrev_b32 v9, 4, v9
    v_and_b32 v8, 1, v8
    v_lshl_add_u32 v9, v8, 9, v9
    v_lshl_add_u32 v9, v7, 12, v9
    v_xor_b32 v10, 64, v9
    s_lshl_b32 s60, s60, 12
    s_lshr_b32 s76, s35, 1
    s_lshl_b32 s76, s76, 10
    s_add_u32 s60, s60, s76
    s_and_b32 s76, s35, 1
    s_lshl_b32 s76, s76, 8
    s_add_u32 s60, s60, s76
    s_and_b32 s76, s62, 1
    s_lshl_b32 s76, s76, 7
    s_add_u32 s60, s60, s76
    s_add_u32 s60, s60, 10485760
    s_and_b32 s76, s3, 1
    s_mul_i32 s76, s76, 4160
    s_add_u32 m0, s76, s38
    s_add_u32 s22, s32, s61
    s_addc_u32 s23, s33, 0
    s_mov_b32 s79, 0
SP39:
    s_load_dword s64, s[22:23], 0 glc
    s_load_dword s65, s[22:23], 128 glc
    s_load_dword s66, s[22:23], 256 glc
    s_load_dword s67, s[22:23], 384 glc
    s_load_dword s68, s[22:23], 512 glc
    s_load_dword s69, s[22:23], 640 glc
    s_load_dword s70, s[22:23], 768 glc
    s_load_dword s71, s[22:23], 896 glc
    s_load_dword s72, s[22:23], 1024 glc
    s_load_dword s73, s[22:23], 1152 glc
    s_load_dword s74, s[22:23], 1280 glc
    s_load_dword s75, s[22:23], 1408 glc
    s_load_dword s16, s[22:23], 1536 glc
    s_load_dword s17, s[22:23], 1664 glc
    s_load_dword s18, s[22:23], 1792 glc
    s_load_dword s19, s[22:23], 1920 glc
    s_add_u32 s79, s79, 1
    s_waitcnt lgkmcnt(0)
    s_xor_b32 s76, s64, s21
    s_xor_b32 s77, s65, s21
    s_or_b32 s76, s76, s77
    s_xor_b32 s77, s66, s21
    s_or_b32 s76, s76, s77
    s_xor_b32 s77, s67, s21
    s_or_b32 s76, s76, s77
    s_xor_b32 s77, s68, s21
    s_or_b32 s76, s76, s77
    s_xor_b32 s77, s69, s21
    s_or_b32 s76, s76, s77
    s_xor_b32 s77, s70, s21
    s_or_b32 s76, s76, s77
    s_xor_b32 s77, s71, s21
    s_or_b32 s76, s76, s77
    s_xor_b32 s77, s72, s21
    s_or_b32 s76, s76, s77
    s_xor_b32 s77, s73, s21
    s_or_b32 s76, s76, s77
    s_xor_b32 s77, s74, s21
    s_or_b32 s76, s76, s77
    s_xor_b32 s77, s75, s21
    s_or_b32 s76, s76, s77
    s_xor_b32 s77, s16, s21
    s_or_b32 s76, s76, s77
    s_xor_b32 s77, s17, s21
    s_or_b32 s76, s76, s77
    s_xor_b32 s77, s18, s21
    s_or_b32 s76, s76, s77
    s_xor_b32 s77, s19, s21
    s_or_b32 s76, s76, s77
    s_cbranch_scc0 SE40
    s_sleep 4
    s_cmp_gt_u32 s79, 32768
    s_cbranch_scc0 SP39
SE40:
    s_barrier
    s_add_u32 s76, s60, 0
    buffer_load_dwordx4 v9, s[52:55], s76 offen offset:0 sc1 lds
    s_add_u32 s76, s60, 15360
    buffer_load_dwordx4 v10, s[52:55], s76 offen offset:1024 sc1 lds
    s_add_u32 s76, s60, 30720
    buffer_load_dwordx4 v9, s[52:55], s76 offen offset:2048 sc1 lds
    s_add_u32 s76, s60, 46080
    buffer_load_dwordx4 v10, s[52:55], s76 offen offset:3072 sc1 lds
    s_waitcnt vmcnt(0)
    s_barrier
    s_branch L_FIN
L_LN:
    v_lshrrev_b32 v4, 4, v1
    v_and_b32 v5, 15, v1
    s_and_b32 s76, s34, 1
    s_lshl_b32 s76, s76, 3
    s_and_b32 s77, s34, 4
    s_add_u32 s76, s76, s77
    v_add_u32 v6, s76, v4
    v_mul_u32_u24 v6, 2592, v6
    v_lshl_add_u32 v6, v5, 3, v6
    s_and_b32 s76, s34, 2
    s_lshl_b32 s76, s76, 1
    v_add_u32 v6, s76, v6
    v_and_b32 v7, 1, v1
    v_bfe_u32 v8, v1, 2, 2
    v_lshl_add_u32 v7, v7, 2, v8
    v_mul_u32_u24 v7, 2592, v7
    v_lshl_add_u32 v7, v4, 4, v7
    v_bfe_u32 v8, v1, 1, 1
    v_lshl_add_u32 v7, v8, 3, v7
    s_mul_i32 s76, s34, 320
    v_add_u32 v7, s76, v7
    v_lshrrev_b32 v8, 3, v1
    v_lshlrev_b32 v8, 15, v8
    v_and_b32 v10, 7, v1
    v_lshl_add_u32 v8, v10, 4, v8
    s_and_b32 s65, s34, 1
    s_mul_i32 s65, s65, 160
    s_lshr_b32 s76, s34, 1
    s_add_u32 s65, s65, s76
    s_lshl_b32 s65, s65, 13
    s_lshl_b32 s76, s62, 7
    s_add_u32 s65, s65, s76
    v_mov_b32 v10, 0
    v_mov_b32 v11, 0
    v_mov_b32 v12, 0
    v_mov_b32 v13, 0
    s_cmp_ge_u32 s34, 4
    s_cbranch_scc0 WL41
    s_and_b32 s76, s35, 1
    s_mul_i32 s76, s76, 6
    s_sub_u32 s77, s36, 24
    s_add_u32 s28, s76, s77
    s_mul_i32 s77, s77, 27
    s_lshr_b32 s77, s77, 4
    s_lshl_b32 s77, s77, 6
    s_lshr_b32 s29, s35, 1
    s_mul_i32 s76, s29, 160
    s_add_u32 s76, s76, s77
    s_mul_i32 s76, s76, 3072
    s_lshl_b32 s77, s28, 2
    s_add_u32 s77, s77, s34
    s_sub_u32 s77, s77, 4
    s_lshl_b32 s77, s77, 6
    s_cmp_lt_u32 s36, 30
    s_cselect_b32 s18, s77, 0x40000000
    s_cselect_b32 s77, s77, 0
    v_lshrrev_b32 v9, 2, v1
    v_mul_u32_u24 v9, 3072, v9
    v_and_b32 v189, 3, v1
    v_lshl_add_u32 v9, v189, 4, v9
    v_add_u32 v9, s18, v9
    s_sub_u32 s18, s76, 1966080
    s_min_u32 s76, s76, s18
    buffer_load_dwordx4 v[148:151], v9, s[44:47], s76 offen
    s_add_u32 s76, s76, 49152
    s_sub_u32 s18, s76, 1966080
    s_min_u32 s76, s76, s18
    buffer_load_dwordx4 v[152:155], v9, s[44:47], s76 offen
    s_add_u32 s76, s76, 49152
    s_sub_u32 s18, s76, 1966080
    s_min_u32 s76, s76, s18
    buffer_load_dwordx4 v[156:159], v9, s[44:47], s76 offen
    s_add_u32 s76, s76, 49152
    s_sub_u32 s18, s76, 1966080
    s_min_u32 s76, s76, s18
    buffer_load_dwordx4 v[160:163], v9, s[44:47], s76 offen
    s_add_u32 s76, s76, 49152
    s_sub_u32 s18, s76, 1966080
    s_min_u32 s76, s76, s18
    buffer_load_dwordx4 v[164:167], v9, s[44:47], s76 offen
    s_add_u32 s76, s76, 49152
    s_sub_u32 s18, s76, 1966080
    s_min_u32 s76, s76, s18
    buffer_load_dwordx4 v[168:171], v9, s[44:47], s76 offen
    s_add_u32 s76, s76, 49152
    s_sub_u32 s18, s76, 1966080
    s_min_u32 s76, s76, s18
    buffer_load_dwordx4 v[172:175], v9, s[44:47], s76 offen
    s_add_u32 s76, s76, 49152
    s_sub_u32 s18, s76, 1966080
    s_min_u32 s76, s76, s18
    buffer_load_dwordx4 v[176:179], v9, s[44:47], s76 offen
    s_add_u32 s76, s76, 49152
    s_sub_u32 s18, s76, 1966080
    s_min_u32 s76, s76, s18
    buffer_load_dwordx4 v[180:183], v9, s[44:47], s76 offen
    s_add_u32 s76, s76, 49152
    s_sub_u32 s18, s76, 1966080
    s_min_u32 s76, s76, s18
    buffer_load_dwordx4 v[184:187], v9, s[44:47], s76 offen
    s_add_u32 s76, s76, 49152
    v_lshlrev_b32 v189, 3, v189
    v_lshl_add_u32 v189, v4, 1, v189
    v_bfe_u32 v9, v1, 2, 1
    v_add_u32 v189, v189, v9
    v_lshl_add_u32 v9, v189, 1, s77
    v_mov_b32 v188, 0
    global_load_short_d16_hi v188, v9, s[22:23]
WL41:
    s_waitcnt vmcnt(11)
    s_cmp_ge_u32 s34, 4
    s_cbranch_scc1 WW42
    s_waitcnt vmcnt(0)
WW42:
    v_lshlrev_b32_e64 v100, 16, v228
    v_and_b32 v101, 0xffff0000, v228
    v_pk_add_f32 v[10:11], v[10:11], v[100:101]
    v_pk_fma_f32 v[12:13], v[100:101], v[100:101], v[12:13]
    v_lshlrev_b32_e64 v102, 16, v229
    v_and_b32 v103, 0xffff0000, v229
    v_pk_add_f32 v[10:11], v[10:11], v[102:103]
    v_pk_fma_f32 v[12:13], v[102:103], v[102:103], v[12:13]
    v_lshlrev_b32_e64 v104, 16, v230
    v_and_b32 v105, 0xffff0000, v230
    v_pk_add_f32 v[10:11], v[10:11], v[104:105]
    v_pk_fma_f32 v[12:13], v[104:105], v[104:105], v[12:13]
    v_lshlrev_b32_e64 v106, 16, v231
    v_and_b32 v107, 0xffff0000, v231
    v_pk_add_f32 v[10:11], v[10:11], v[106:107]
    v_pk_fma_f32 v[12:13], v[106:107], v[106:107], v[12:13]
    v_lshlrev_b32_e64 v108, 16, v232
    v_and_b32 v109, 0xffff0000, v232
    v_pk_add_f32 v[10:11], v[10:11], v[108:109]
    v_pk_fma_f32 v[12:13], v[108:109], v[108:109], v[12:13]
    v_lshlrev_b32_e64 v110, 16, v233
    v_and_b32 v111, 0xffff0000, v233
    v_pk_add_f32 v[10:11], v[10:11], v[110:111]
    v_pk_fma_f32 v[12:13], v[110:111], v[110:111], v[12:13]
    v_lshlrev_b32_e64 v112, 16, v234
    v_and_b32 v113, 0xffff0000, v234
    v_pk_add_f32 v[10:11], v[10:11], v[112:113]
    v_pk_fma_f32 v[12:13], v[112:113], v[112:113], v[12:13]
    v_lshlrev_b32_e64 v114, 16, v235
    v_and_b32 v115, 0xffff0000, v235
    v_pk_add_f32 v[10:11], v[10:11], v[114:115]
    v_pk_fma_f32 v[12:13], v[114:115], v[114:115], v[12:13]
    v_lshlrev_b32_e64 v116, 16, v236
    v_and_b32 v117, 0xffff0000, v236
    v_pk_add_f32 v[10:11], v[10:11], v[116:117]
    v_pk_fma_f32 v[12:13], v[116:117], v[116:117], v[12:13]
    v_lshlrev_b32_e64 v118, 16, v237
    v_and_b32 v119, 0xffff0000, v237
    v_pk_add_f32 v[10:11], v[10:11], v[118:119]
    v_pk_fma_f32 v[12:13], v[118:119], v[118:119], v[12:13]
    v_lshlrev_b32_e64 v120, 16, v238
    v_and_b32 v121, 0xffff0000, v238
    v_pk_add_f32 v[10:11], v[10:11], v[120:121]
    v_pk_fma_f32 v[12:13], v[120:121], v[120:121], v[12:13]
    v_lshlrev_b32_e64 v122, 16, v239
    v_and_b32 v123, 0xffff0000, v239
    v_pk_add_f32 v[10:11], v[10:11], v[122:123]
    v_pk_fma_f32 v[12:13], v[122:123], v[122:123], v[12:13]
    v_lshlrev_b32_e64 v124, 16, v240
    v_and_b32 v125, 0xffff0000, v240
    v_pk_add_f32 v[10:11], v[10:11], v[124:125]
    v_pk_fma_f32 v[12:13], v[124:125], v[124:125], v[12:13]
    v_lshlrev_b32_e64 v126, 16, v241
    v_and_b32 v127, 0xffff0000, v241
PADS3:
    s_cbranch_execz WR3
    v_pk_add_f32 v[10:11], v[10:11], v[126:127]
    v_pk_fma_f32 v[12:13], v[126:127], v[126:127], v[12:13]
    v_lshlrev_b32 v128, 16, v242
    v_and_b32 v129, 0xffff0000, v242
    v_pk_add_f32 v[10:11], v[10:11], v[128:129]
    v_pk_fma_f32 v[12:13], v[128:129], v[128:129], v[12:13]
    v_lshlrev_b32_e64 v130, 16, v243
    v_and_b32 v131, 0xffff0000, v243
    v_pk_add_f32 v[10:11], v[10:11], v[130:131]
    v_pk_fma_f32 v[12:13], v[130:131], v[130:131], v[12:13]
    v_lshlrev_b32_e64 v132, 16, v244
    v_and_b32 v133, 0xffff0000, v244
    v_pk_add_f32 v[10:11], v[10:11], v[132:133]
    v_pk_fma_f32 v[12:13], v[132:133], v[132:133], v[12:13]
    v_lshlrev_b32_e64 v134, 16, v245
    v_and_b32 v135, 0xffff0000, v245
    v_pk_add_f32 v[10:11], v[10:11], v[134:135]
    v_pk_fma_f32 v[12:13], v[134:135], v[134:135], v[12:13]
    v_lshlrev_b32_e64 v136, 16, v246
    v_and_b32 v137, 0xffff0000, v246
    v_pk_add_f32 v[10:11], v[10:11], v[136:137]
    v_pk_fma_f32 v[12:13], v[136:137], v[136:137], v[12:13]
    v_lshlrev_b32_e64 v138, 16, v247
    v_and_b32 v139, 0xffff0000, v247
    v_pk_add_f32 v[10:11], v[10:11], v[138:139]
    v_pk_fma_f32 v[12:13], v[138:139], v[138:139], v[12:13]
    v_add_f32 v10, v10, v11
    v_add_f32 v12, v12, v13
    s_nop 0
    v_add_f32 v10, v10, v10 row_ror:8
    v_add_f32 v12, v12, v12 row_ror:8
    s_nop 0
    v_add_f32 v10, v10, v10 row_ror:4
    v_add_f32 v12, v12, v12 row_ror:4
    s_nop 0
    v_add_f32 v10, v10, v10 row_ror:2
    v_add_f32 v12, v12, v12 row_ror:2
    s_nop 0
    v_add_f32 v10, v10, v10 row_ror:1
    v_add_f32 v12, v12, v12 row_ror:1
    v_mul_f32 v10, 0x3acccccd, v10
    v_mul_f32 v12, 0x3acccccd, v12
    v_fma_f32 v12, -v10, v10, v12
    v_max_f32 v12, 0, v12
    v_cvt_pk_bf16_f32 v11, v10, v10
    v_lshlrev_b32 v11, 16, v11
    v_cvt_pk_bf16_f32 v13, v12, v12
    v_lshlrev_b32_e64 v13, 16, v13
    v_add_f32 v13, 0x3727c5ac, v13
    v_cvt_pk_bf16_f32 v13, v13, v13
    v_lshlrev_b32 v13, 16, v13
    v_sqrt_f32 v13, v13
    s_nop 0
    v_cvt_pk_bf16_f32 v13, v13, v13
    v_lshlrev_b32 v13, 16, v13
    v_rcp_f32 v14, v13
    s_nop 0
    v_mul_f32 v15, v11, v14
    v_sub_f32 v15, 0, v15
    v_sub_f32 v10, v10, v11
    v_mul_f32 v10, v10, v14
    v_cvt_pk_bf16_f32 v10, v10, v10
    v_lshlrev_b32 v10, 16, v10
    v_mul_f32 v12, v12, v14
    v_mul_f32 v12, v12, v14
    v_cvt_pk_bf16_f32 v12, v12, v12
    v_lshlrev_b32 v12, 16, v12
    v_add_f32 v12, 0x3727c5ac, v12
    v_cvt_pk_bf16_f32 v12, v12, v12
    v_lshlrev_b32 v12, 16, v12
    v_sqrt_f32 v12, v12
    s_nop 0
    v_cvt_pk_bf16_f32 v12, v12, v12
    v_lshlrev_b32 v12, 16, v12
    v_fma_f32 v10, -v10, v13, -v11
    v_mul_f32 v12, v13, v12
    v_rcp_f32 v9, v12
    v_cvt_pk_bf16_f32 v140, v10, v10
    v_and_b32 v11, 0xffff0000, v140
    v_sub_f32_e64 v11, v10, v11
    v_cvt_pk_bf16_f32 v141, v11, v12
    v_and_b32 v11, 0xffff0000, v141
    v_sub_f32_e64 v11, v12, v11
    v_cvt_pk_bf16_f32 v142, v11, 0
    v_mul_f32 v13, 0xc0135761, v9
    v_mul_f32 v9, v9, v9
    v_mul_f32 v9, 0x3d372713, v9
    v_mul_f32 v9, v9, v13
    v_cmp_eq_u32 vcc, 1, v5
    s_lshl_b32 s67, s63, 5
    s_add_u32 s67, s67, 14090240
    v_mov_b32 v143, 0
    v_cndmask_b32 v140, v140, v9, vcc
    v_cndmask_b32 v141, v141, v13, vcc
    v_cndmask_b32 v142, v142, v12, vcc
    v_lshlrev_b32 v9, 5, v4
    v_lshl_add_u32 v9, v5, 4, v9
    v_cmp_gt_u32 vcc, 2, v5
    s_nop 0
    s_and_saveexec_b64 s[68:69], vcc
    buffer_store_dwordx4 v[140:143], v9, s[52:55], s67 offen sc1
    s_mov_b64 exec, s[68:69]
    s_nop 0
    v_pk_fma_f32 v[100:101], v[100:101], v[14:15], v[14:15] op_sel:[0,0,1] op_sel_hi:[1,0,1]
    v_cvt_pk_bf16_f32 v228, v100, v101
    v_pk_fma_f32 v[102:103], v[102:103], v[14:15], v[14:15] op_sel:[0,0,1] op_sel_hi:[1,0,1]
    v_cvt_pk_bf16_f32 v229, v102, v103
    v_pk_fma_f32 v[104:105], v[104:105], v[14:15], v[14:15] op_sel:[0,0,1] op_sel_hi:[1,0,1]
    v_cvt_pk_bf16_f32 v230, v104, v105
    v_pk_fma_f32 v[106:107], v[106:107], v[14:15], v[14:15] op_sel:[0,0,1] op_sel_hi:[1,0,1]
    v_cvt_pk_bf16_f32 v231, v106, v107
    ds_write_b32 v6, v228 offset:0
    ds_write_b32 v6, v229 offset:640
    ds_write_b32 v6, v230 offset:1280
    ds_write_b32 v6, v231 offset:1920
    v_pk_fma_f32 v[108:109], v[108:109], v[14:15], v[14:15] op_sel:[0,0,1] op_sel_hi:[1,0,1]
    v_cvt_pk_bf16_f32 v232, v108, v109
    v_pk_fma_f32 v[110:111], v[110:111], v[14:15], v[14:15] op_sel:[0,0,1] op_sel_hi:[1,0,1]
    v_cvt_pk_bf16_f32 v233, v110, v111
    v_pk_fma_f32 v[112:113], v[112:113], v[14:15], v[14:15] op_sel:[0,0,1] op_sel_hi:[1,0,1]
    v_cvt_pk_bf16_f32 v234, v112, v113
    v_pk_fma_f32 v[114:115], v[114:115], v[14:15], v[14:15] op_sel:[0,0,1] op_sel_hi:[1,0,1]
    v_cvt_pk_bf16_f32 v235, v114, v115
    ds_write_b32 v6, v232 offset:128
    ds_write_b32 v6, v233 offset:768
    ds_write_b32 v6, v234 offset:1408
    ds_write_b32 v6, v235 offset:2048
    v_pk_fma_f32 v[116:117], v[116:117], v[14:15], v[14:15] op_sel:[0,0,1] op_sel_hi:[1,0,1]
    v_cvt_pk_bf16_f32 v236, v116, v117
    v_pk_fma_f32 v[118:119], v[118:119], v[14:15], v[14:15] op_sel:[0,0,1] op_sel_hi:[1,0,1]
    v_cvt_pk_bf16_f32 v237, v118, v119
    v_pk_fma_f32 v[120:121], v[120:121], v[14:15], v[14:15] op_sel:[0,0,1] op_sel_hi:[1,0,1]
    v_cvt_pk_bf16_f32 v238, v120, v121
    v_pk_fma_f32 v[122:123], v[122:123], v[14:15], v[14:15] op_sel:[0,0,1] op_sel_hi:[1,0,1]
    v_cvt_pk_bf16_f32 v239, v122, v123
    ds_write_b32 v6, v236 offset:256
    ds_write_b32 v6, v237 offset:896
    ds_write_b32 v6, v238 offset:1536
    ds_write_b32 v6, v239 offset:2176
    v_pk_fma_f32 v[124:125], v[124:125], v[14:15], v[14:15] op_sel:[0,0,1] op_sel_hi:[1,0,1]
    v_cvt_pk_bf16_f32 v240, v124, v125
    v_pk_fma_f32 v[126:127], v[126:127], v[14:15], v[14:15] op_sel:[0,0,1] op_sel_hi:[1,0,1]
    v_cvt_pk_bf16_f32 v241, v126, v127
    v_pk_fma_f32 v[128:129], v[128:129], v[14:15], v[14:15] op_sel:[0,0,1] op_sel_hi:[1,0,1]
    v_cvt_pk_bf16_f32 v242, v128, v129
    v_pk_fma_f32 v[130:131], v[130:131], v[14:15], v[14:15] op_sel:[0,0,1] op_sel_hi:[1,0,1]
    v_cvt_pk_bf16_f32 v243, v130, v131
    ds_write_b32 v6, v240 offset:384
    ds_write_b32 v6, v241 offset:1024
    ds_write_b32 v6, v242 offset:1664
    ds_write_b32 v6, v243 offset:2304
    v_pk_fma_f32 v[132:133], v[132:133], v[14:15], v[14:15] op_sel:[0,0,1] op_sel_hi:[1,0,1]
    v_cvt_pk_bf16_f32 v244, v132, v133
    v_pk_fma_f32 v[134:135], v[134:135], v[14:15], v[14:15] op_sel:[0,0,1] op_sel_hi:[1,0,1]
    v_cvt_pk_bf16_f32 v245, v134, v135
    v_pk_fma_f32 v[136:137], v[136:137], v[14:15], v[14:15] op_sel:[0,0,1] op_sel_hi:[1,0,1]
    v_cvt_pk_bf16_f32 v246, v136, v137
    v_pk_fma_f32 v[138:139], v[138:139], v[14:15], v[14:15] op_sel:[0,0,1] op_sel_hi:[1,0,1]
    v_cvt_pk_bf16_f32 v247, v138, v139
    ds_write_b32 v6, v244 offset:512
    ds_write_b32 v6, v245 offset:1152
    ds_write_b32 v6, v246 offset:1792
    ds_write_b32 v6, v247 offset:2432
    s_cmp_ge_u32 s34, 4
    s_cbranch_scc0 L_CSB
    s_cmp_lt_u32 s36, 30
    s_cbranch_scc0 L_CSB
    s_waitcnt vmcnt(1)
    v_lshlrev_b32 v100, 16, v148
    v_and_b32 v101, 0xffff0000, v148
    v_lshlrev_b32 v102, 16, v149
    v_and_b32 v103, 0xffff0000, v149
    v_lshlrev_b32 v104, 16, v150
    v_and_b32 v105, 0xffff0000, v150
    v_lshlrev_b32 v106, 16, v151
    v_and_b32 v107, 0xffff0000, v151
    v_lshlrev_b32 v108, 16, v152
    v_and_b32 v109, 0xffff0000, v152
    v_lshlrev_b32 v110, 16, v153
    v_and_b32 v111, 0xffff0000, v153
    v_lshlrev_b32 v112, 16, v154
    v_and_b32 v113, 0xffff0000, v154
    v_lshlrev_b32_e64 v114, 16, v155
    v_and_b32 v115, 0xffff0000, v155
    v_pk_add_f32 v[100:101], v[100:101], v[108:109]
    v_pk_add_f32 v[102:103], v[102:103], v[110:111]
    v_pk_add_f32 v[104:105], v[104:105], v[112:113]
    v_pk_add_f32 v[106:107], v[106:107], v[114:115]
    v_lshlrev_b32 v108, 16, v156
    v_and_b32 v109, 0xffff0000, v156
    v_lshlrev_b32 v110, 16, v157
    v_and_b32 v111, 0xffff0000, v157
    v_lshlrev_b32 v112, 16, v158
    v_and_b32 v113, 0xffff0000, v158
    v_lshlrev_b32 v114, 16, v159
    v_and_b32 v115, 0xffff0000, v159
    v_pk_add_f32 v[100:101], v[100:101], v[108:109]
    v_pk_add_f32 v[102:103], v[102:103], v[110:111]
    v_pk_add_f32 v[104:105], v[104:105], v[112:113]
    v_pk_add_f32 v[106:107], v[106:107], v[114:115]
    v_lshlrev_b32 v108, 16, v160
    v_and_b32 v109, 0xffff0000, v160
    v_lshlrev_b32 v110, 16, v161
    v_and_b32 v111, 0xffff0000, v161
    v_lshlrev_b32 v112, 16, v162
    v_and_b32 v113, 0xffff0000, v162
    v_lshlrev_b32 v114, 16, v163
    v_and_b32 v115, 0xffff0000, v163
    v_pk_add_f32 v[100:101], v[100:101], v[108:109]
    v_pk_add_f32 v[102:103], v[102:103], v[110:111]
    v_pk_add_f32 v[104:105], v[104:105], v[112:113]
    v_pk_add_f32 v[106:107], v[106:107], v[114:115]
    v_lshlrev_b32 v108, 16, v164
    v_and_b32 v109, 0xffff0000, v164
    v_lshlrev_b32 v110, 16, v165
    v_and_b32 v111, 0xffff0000, v165
    v_lshlrev_b32 v112, 16, v166
    v_and_b32 v113, 0xffff0000, v166
    v_lshlrev_b32 v114, 16, v167
    v_and_b32 v115, 0xffff0000, v167
    v_pk_add_f32 v[100:101], v[100:101], v[108:109]
    v_pk_add_f32 v[102:103], v[102:103], v[110:111]
    v_pk_add_f32 v[104:105], v[104:105], v[112:113]
    v_pk_add_f32 v[106:107], v[106:107], v[114:115]
    v_lshlrev_b32 v108, 16, v168
    v_and_b32 v109, 0xffff0000, v168
    v_lshlrev_b32 v110, 16, v169
    v_and_b32 v111, 0xffff0000, v169
    v_lshlrev_b32 v112, 16, v170
    v_and_b32 v113, 0xffff0000, v170
    v_lshlrev_b32 v114, 16, v171
    v_and_b32 v115, 0xffff0000, v171
    v_pk_add_f32 v[100:101], v[100:101], v[108:109]
    v_pk_add_f32 v[102:103], v[102:103], v[110:111]
    v_pk_add_f32 v[104:105], v[104:105], v[112:113]
    v_pk_add_f32 v[106:107], v[106:107], v[114:115]
    v_lshlrev_b32 v108, 16, v172
    v_and_b32 v109, 0xffff0000, v172
    v_lshlrev_b32 v110, 16, v173
    v_and_b32 v111, 0xffff0000, v173
    v_lshlrev_b32 v112, 16, v174
    v_and_b32 v113, 0xffff0000, v174
    v_lshlrev_b32 v114, 16, v175
    v_and_b32 v115, 0xffff0000, v175
    v_pk_add_f32 v[100:101], v[100:101], v[108:109]
    v_pk_add_f32 v[102:103], v[102:103], v[110:111]
    v_pk_add_f32 v[104:105], v[104:105], v[112:113]
    v_pk_add_f32 v[106:107], v[106:107], v[114:115]
    v_lshlrev_b32 v108, 16, v176
    v_and_b32 v109, 0xffff0000, v176
    v_lshlrev_b32 v110, 16, v177
    v_and_b32 v111, 0xffff0000, v177
    v_lshlrev_b32 v112, 16, v178
    v_and_b32 v113, 0xffff0000, v178
    v_lshlrev_b32 v114, 16, v179
    v_and_b32 v115, 0xffff0000, v179
    v_pk_add_f32 v[100:101], v[100:101], v[108:109]
    v_pk_add_f32 v[102:103], v[102:103], v[110:111]
    v_pk_add_f32 v[104:105], v[104:105], v[112:113]
    v_pk_add_f32 v[106:107], v[106:107], v[114:115]
    v_lshlrev_b32 v108, 16, v180
    v_and_b32 v109, 0xffff0000, v180
    v_lshlrev_b32 v110, 16, v181
    v_and_b32 v111, 0xffff0000, v181
    v_lshlrev_b32 v112, 16, v182
    v_and_b32 v113, 0xffff0000, v182
    v_lshlrev_b32 v114, 16, v183
    v_and_b32 v115, 0xffff0000, v183
    v_pk_add_f32 v[100:101], v[100:101], v[108:109]
    v_pk_add_f32 v[102:103], v[102:103], v[110:111]
    v_pk_add_f32 v[104:105], v[104:105], v[112:113]
    v_pk_add_f32 v[106:107], v[106:107], v[114:115]
    v_lshlrev_b32 v108, 16, v184
    v_and_b32 v109, 0xffff0000, v184
    v_lshlrev_b32 v110, 16, v185
    v_and_b32 v111, 0xffff0000, v185
    v_lshlrev_b32 v112, 16, v186
    v_and_b32 v113, 0xffff0000, v186
    v_lshlrev_b32 v114, 16, v187
    v_and_b32 v115, 0xffff0000, v187
    v_pk_add_f32 v[100:101], v[100:101], v[108:109]
    v_pk_add_f32 v[102:103], v[102:103], v[110:111]
    v_pk_add_f32 v[104:105], v[104:105], v[112:113]
    v_pk_add_f32 v[106:107], v[106:107], v[114:115]
    s_cmp_eq_u32 s29, 0
    s_cselect_b32 s76, -1, 0
    v_and_b32 v188, s76, v188
    v_and_b32 v9, 4, v1
    v_cmp_ne_u32 vcc, 0, v9
    v_permlane32_swap_b32 v100, v104
    v_permlane32_swap_b32 v101, v105
    v_permlane32_swap_b32 v102, v106
    v_permlane32_swap_b32 v103, v107
    v_pk_add_f32 v[100:101], v[100:101], v[104:105]
    v_pk_add_f32 v[102:103], v[102:103], v[106:107]
    s_lshl_b32 s76, s28, 2
    s_add_u32 s76, s76, s29
    s_lshl_b32 s76, s76, 2
    s_add_u32 s76, s76, s34
    s_lshl_b32 s76, s76, 9
    s_add_u32 s76, s76, 14153728
    v_permlane16_swap_b32 v100, v102
    v_permlane16_swap_b32 v101, v103
    v_pk_add_f32 v[100:101], v[100:101], v[102:103]
    v_lshlrev_b32 v9, 4, v189
    v_lshrrev_b32 v12, 16, v188
    v_add_f32 v100, v100, v100 row_ror:8
    v_add_f32 v101, v101, v101 row_ror:8
    v_mov_b32_e64 v13, 0
    v_add_f32 v100, v100, v100 row_ror:4
    v_add_f32 v101, v101, v101 row_ror:4
    v_cndmask_b32 v100, v100, v101, vcc
    v_cvt_pk_bf16_f32 v11, v100, v188
    v_lshlrev_b32 v10, 16, v11
    v_sub_f32_e64 v10, v100, v10
    v_cvt_pk_bf16_f32 v10, v100, v10
    s_mov_b32 exec_lo, 0x00ff00ff
    s_mov_b32 exec_hi, 0x00ff00ff
    buffer_store_dwordx4 v[10:13], v9, s[52:55], s76 offen sc1
    s_mov_b64 exec, -1
L_CSB:
    s_waitcnt vmcnt(0) lgkmcnt(0)
    s_barrier
    s_cmp_eq_u32 s34, 4
    s_cbranch_scc0 YF43
    s_lshl_b32 s76, s62, 7
    s_add_u32 s76, s76, 13672448
    v_mov_b32 v250, s21
    v_mov_b32 v251, s21
    v_mov_b32 v252, s21
    v_mov_b32 v253, s21
    v_lshlrev_b32_e64 v254, 4, v1
    s_mov_b64 exec, 0xff
    buffer_store_dwordx4 v[250:253], v254, s[52:55], s76 offen sc1
    s_mov_b64 exec, -1
YF43:
    s_nop 0
    ds_read_b64_tr_b16 v[228:229], v7 offset:0
    ds_read_b64_tr_b16 v[230:231], v7 offset:20736
    ds_read_b64_tr_b16 v[232:233], v7 offset:64
    ds_read_b64_tr_b16 v[234:235], v7 offset:20800
    ds_read_b64_tr_b16 v[236:237], v7 offset:128
    ds_read_b64_tr_b16 v[238:239], v7 offset:20864
    ds_read_b64_tr_b16 v[240:241], v7 offset:192
    ds_read_b64_tr_b16 v[242:243], v7 offset:20928
    ds_read_b64_tr_b16 v[244:245], v7 offset:256
    ds_read_b64_tr_b16 v[246:247], v7 offset:20992
    s_waitcnt lgkmcnt(8)
    s_add_u32 s76, s65, 0
    buffer_store_dwordx4 v[228:231], v8, s[52:55], s76 offen sc1
    s_waitcnt lgkmcnt(6)
    s_add_u32 s76, s65, 262144
    buffer_store_dwordx4 v[232:235], v8, s[52:55], s76 offen sc1
    s_waitcnt lgkmcnt(4)
    s_add_u32 s76, s65, 524288
    buffer_store_dwordx4 v[236:239], v8, s[52:55], s76 offen sc1
    s_waitcnt lgkmcnt(2)
    s_add_u32 s76, s65, 786432
    buffer_store_dwordx4 v[240:243], v8, s[52:55], s76 offen sc1
    s_waitcnt lgkmcnt(0)
    s_add_u32 s76, s65, 1048576
    buffer_store_dwordx4 v[244:247], v8, s[52:55], s76 offen sc1
    s_cmp_eq_u32 s19, -1
    s_cbranch_scc1 L_LNRm
    s_nop 0
    s_branch L_LNR0
L_GE:
    s_setprio 1
    s_mul_i32 s68, s36, 43
    s_lshr_b32 s68, s68, 8
    s_mul_i32 s69, s68, 6
    s_sub_u32 s69, s36, s69
    s_lshr_b32 s64, s35, 1
    s_and_b32 s65, s35, 1
    s_lshl_b32 s37, s64, 2
    s_add_u32 s37, s37, s68
    s_mul_i32 s38, s65, 6
    s_add_u32 s38, s38, s69
    s_mov_b32 s39, 0
    s_add_u32 s64, s64, 1
    s_mul_i32 s66, s68, 32
    s_lshr_b32 s66, s66, 4
    s_add_u32 s39, s39, s66
    s_mul_i32 s66, s69, 27
    s_lshr_b32 s66, s66, 4
    s_add_u32 s39, s39, s66
    s_mul_i32 s66, s64, 40
    s_lshr_b32 s66, s66, 4
    s_add_u32 s39, s39, s66
    s_mul_i32 s66, s39, 26
    s_lshr_b32 s66, s66, 8
    s_mul_i32 s66, s66, 10
    s_sub_u32 s39, s39, s66
    s_lshl_b32 s76, s37, 7
    s_lshl_b32 s77, s34, 5
    s_add_u32 s76, s76, s77
    s_mul_i32 s76, s76, 1280
    v_lshrrev_b32 v2, 3, v1
    v_mul_u32_u24 v2, 1280, v2
    v_lshrrev_b32 v3, 4, v1
    v_xor_b32 v4, v3, v1
    v_and_b32 v4, 7, v4
    v_lshl_add_u32 v2, v4, 4, v2
    v_add_u32 v16, s76, v2
    v_xor_b32_e64 v2, 64, v16
    v_add_u32 v17, 9216, v2
    v_add_u32 v18, 18432, v16
    v_add_u32 v19, 27648, v2
    s_mul_i32 s76, s34, 49152
    s_lshl_b32 s77, s38, 8
    s_add_u32 s76, s76, s77
    v_mul_u32_u24 v2, 3072, v3
    v_lshlrev_b32 v4, 2, v3
    v_xor_b32 v4, v4, v1
    v_and_b32 v4, 15, v4
    v_lshl_add_u32 v2, v4, 4, v2
    v_add_u32 v20, s76, v2
    v_xor_b32_e64 v2, 16, v20
    v_add_u32 v21, 11264, v20
    v_add_u32 v22, 22528, v2
    v_add_u32 v23, 33792, v2
    s_lshl_b32 s67, s34, 12
    s_mov_b32 s42, 2621440
    s_mov_b32 s43, 0x20000
    s_mov_b32 s46, 1966080
    s_mov_b32 s47, 0x20000
    s_waitcnt lgkmcnt(0)
    s_mov_b32 s40, s4
    s_mov_b32 s41, s5
    s_mov_b32 s44, s20
    s_mov_b32 s45, s21
    s_add_u32 m0, s67, 0
    s_lshl_b32 s76, s39, 7
    buffer_load_dwordx4 v16, s[40:43], s76 offen offset:0 lds
    buffer_load_dwordx4 v17, s[40:43], s76 offen offset:1024 lds
    buffer_load_dwordx4 v18, s[40:43], s76 offen offset:2048 lds
    buffer_load_dwordx4 v19, s[40:43], s76 offen offset:3072 lds
    s_add_u32 m0, s67, 65536
    s_mul_i32 s77, s39, 196608
    buffer_load_dwordx4 v20, s[44:47], s77 offen offset:0 lds
    buffer_load_dwordx4 v21, s[44:47], s77 offen offset:1024 lds
    buffer_load_dwordx4 v22, s[44:47], s77 offen offset:2048 lds
    buffer_load_dwordx4 v23, s[44:47], s77 offen offset:3072 lds
    s_add_u32 s39, s39, 1
    s_cmp_eq_u32 s39, 10
    s_cselect_b32 s39, 0, s39
L_G:
    s_nop 0
    s_mov_b32 s42, 2621440
    s_mov_b32 s43, 0x20000
    s_mov_b32 s46, 1966080
    s_mov_b32 s47, 0x20000
    s_mov_b32 s50, 1966080
    s_mov_b32 s51, 0x20000
    s_mov_b32 s54, 16777216
    s_mov_b32 s55, 0x20000
    s_mov_b32 s58, 2621440
    s_mov_b32 s59, 0x20000
    s_mov_b32 s40, s4
    s_mov_b32 s41, s5
    s_mov_b32 s44, s20
    s_mov_b32 s45, s21
    s_mov_b32 s48, s24
    s_mov_b32 s49, s25
    s_mov_b32 s52, s32
    s_mov_b32 s53, s33
    s_mov_b32 s56, s28
    s_mov_b32 s57, s29
    s_mov_b32 s76, 13680640
    s_load_dword s21, s[32:33], s76
    s_cmp_ge_u32 s36, 10
    s_cselect_b32 s62, 1, 0
    s_mul_i32 s63, s62, 10
    s_sub_u32 s63, s36, s63
    s_lshl_b32 s66, s35, 1
    s_add_u32 s62, s62, s66
    s_and_b32 s60, s34, 1
    s_lshr_b32 s61, s34, 1
    v_and_b32 v8, 31, v1
    v_lshrrev_b32 v9, 5, v1
    v_and_b32 v10, 15, v1
    v_lshrrev_b32 v11, 4, v1
    v_bfe_u32 v12, v1, 4, 1
    v_bfe_u32 v13, v1, 2, 2
    v_and_b32 v14, 3, v1
    v_lshrrev_b32 v4, 1, v10
    v_xor_b32 v4, v4, v11
    v_lshlrev_b32 v4, 4, v4
    v_lshl_add_u32 v4, v10, 7, v4
    s_lshl_b32 s76, s61, 13
    v_add_u32 v24, s76, v4
    v_xor_b32 v25, 64, v24
    v_lshl_add_u32 v5, v11, 3, v13
    v_lshlrev_b32 v5, 8, v5
    s_lshl_b32 s76, s60, 1
    v_xor_b32 v4, s76, v13
    v_lshl_add_u32 v5, v4, 6, v5
    v_lshrrev_b32_e64 v4, 1, v14
    v_lshl_add_u32 v5, v4, 5, v5
    v_lshl_add_u32 v5, v12, 4, v5
    v_and_b32_e64 v4, 1, v1
    v_lshl_add_u32 v5, v4, 3, v5
    v_add_u32 v26, 0x10000, v5
    v_xor_b32 v27, 16, v26
    v_xor_b32 v28, 64, v26
    v_xor_b32 v29, 80, v26
    v_lshrrev_b32 v4, 3, v10
    v_lshlrev_b32 v4, 8, v4
    v_and_b32 v5, 7, v1
    v_lshl_add_u32 v4, v5, 4, v4
    v_lshlrev_b32 v5, 11, v11
    s_lshl_b32 s76, s60, 10
    s_add_u32 s76, s76, 148736
    v_add3_u32 v129, v4, v5, s76
    s_lshl_b32 s76, s61, 11
    s_add_u32 s76, s76, 156928
    v_lshl_add_u32 v130, v10, 5, s76
    v_lshlrev_b32 v2, 4, v1
    s_lshl_b32 s76, s37, 1
    s_add_u32 s76, s76, s61
    s_mul_i32 s68, s76, 196608
    s_mul_i32 s3, s76, 3072
    s_lshl_b32 s76, s38, 1
    s_add_u32 s76, s76, s60
    s_lshl_b32 s77, s76, 10
    s_add_u32 s68, s68, s77
    s_add_u32 s68, s68, 4194304
    s_lshl_b32 s76, s76, 7
    s_add_u32 s3, s3, s76
    s_add_u32 s3, s3, 13697024
    s_lshl_b32 s76, s62, 1
    s_add_u32 s76, s76, s61
    s_mul_i32 s72, s76, 81920
    s_mul_i32 s73, s76, 196608
    s_mul_i32 s66, s76, 3072
    s_mul_i32 s77, s60, 12288
    s_add_u32 s73, s73, s77
    s_add_u32 s73, s73, 4194304
    s_mul_i32 s77, s60, 1536
    s_add_u32 s66, s66, s77
    s_add_u32 s66, s66, 13697024
    s_min_u32 s76, s63, 9
    s_lshl_b32 s76, s76, 7
    s_lshl_b32 s77, s60, 6
    s_add_u32 s76, s76, s77
    s_add_u32 s72, s72, s76
    v_lshlrev_b32 v4, 5, v12
    v_lshl_add_u32 v4, v9, 4, v4
    v_add_u32 v31, s76, v4
    v_lshl_add_u32 v4, v12, 1, v9
    s_lshl_b32 s76, s60, 2
    v_lshrrev_b32 v5, 1, v10
    v_xor_b32 v4, v4, v5
    v_xor_b32 v4, s76, v4
    v_lshlrev_b32_e64 v4, 4, v4
    v_lshl_add_u32 v4, v10, 7, v4
    s_mul_i32 s76, s61, 8320
    s_add_u32 s76, s76, 131072
    v_add_u32 v128, s76, v4
    v_lshl_add_u32 v15, v12, 2, v13
    v_lshrrev_b32 v5, 1, v15
    v_lshl_add_u32 v15, v9, 4, v15
    v_lshlrev_b32 v15, 7, v15
    s_lshl_b32 s76, s60, 1
    v_xor_b32_e64 v5, s76, v5
    v_lshl_add_u32 v15, v5, 5, v15
    v_lshl_add_u32 v15, v14, 3, v15
    s_lshl_b32 s76, s60, 12
    s_add_u32 s76, s76, 0x10000
    v_add_u32 v4, s76, v15
    v_xor_b32 v5, 32, v4
    v_xor_b32 v6, 64, v4
    v_xor_b32 v7, 96, v4
    s_lshr_b32 s76, s34, 1
    s_mul_i32 s76, s76, 983040
    s_and_b32 s77, s34, 1
    s_mul_i32 s77, s77, 20480
    s_add_u32 s76, s76, s77
    s_lshl_b32 s77, s63, 7
    s_add_u32 s76, s76, s77
    v_lshrrev_b32 v10, 3, v1
    v_mul_u32_u24 v8, 1280, v10
    v_lshrrev_b32 v10, 4, v1
    v_lshlrev_b32 v10, 1, v10
    v_xor_b32 v10, v10, v1
    v_and_b32 v10, 7, v10
    v_lshl_add_u32 v8, v10, 4, v8
    v_add_u32 v8, s76, v8
    v_add_u32 v9, 9216, v8
    s_lshl_b32 s78, s34, 11
    s_mul_i32 s4, s63, 77
    s_lshr_b32 s4, s4, 6
    s_lshl_b32 s4, s4, 10
    s_add_u32 s5, s4, 1024
    s_cmp_eq_u32 s5, 12288
    s_cselect_b32 s5, 0, s5
    s_add_u32 s6, s5, 1024
    s_cmp_eq_u32 s6, 12288
    s_cselect_b32 s6, 0, s6
    s_add_u32 s7, s6, 1024
    s_cmp_eq_u32 s7, 12288
    s_cselect_b32 s7, 0, s7
    s_add_u32 s8, s7, 1024
    s_cmp_eq_u32 s8, 12288
    s_cselect_b32 s8, 0, s8
    s_add_u32 s9, s8, 1024
    s_cmp_eq_u32 s9, 12288
    s_cselect_b32 s9, 0, s9
    s_add_u32 s10, s9, 1024
    s_cmp_eq_u32 s10, 12288
    s_cselect_b32 s10, 0, s10
    s_add_u32 s11, s10, 1024
    s_cmp_eq_u32 s11, 12288
    s_cselect_b32 s11, 0, s11
    s_add_u32 s12, s11, 1024
    s_cmp_eq_u32 s12, 12288
    s_cselect_b32 s12, 0, s12
    s_add_u32 s13, s12, 1024
    s_cmp_eq_u32 s13, 12288
    s_cselect_b32 s13, 0, s13
    s_add_u32 s14, s13, 1024
    s_cmp_eq_u32 s14, 12288
    s_cselect_b32 s14, 0, s14
    s_add_u32 s15, s14, 1024
    s_cmp_eq_u32 s15, 12288
    s_cselect_b32 s15, 0, s15
    s_nop 0
    global_load_dwordx4 v[12:15], v31, s[26:27]
    s_add_u32 m0, s67, 81920
    s_mul_i32 s77, s39, 196608
    buffer_load_dwordx4 v20, s[44:47], s77 offen offset:0 lds
    buffer_load_dwordx4 v21, s[44:47], s77 offen offset:1024 lds
    buffer_load_dwordx4 v22, s[44:47], s77 offen offset:2048 lds
    buffer_load_dwordx4 v23, s[44:47], s77 offen offset:3072 lds
    s_add_u32 m0, s67, 16384
    s_lshl_b32 s76, s39, 7
    buffer_load_dwordx4 v16, s[40:43], s76 offen offset:0 lds
    buffer_load_dwordx4 v17, s[40:43], s76 offen offset:1024 lds
    buffer_load_dwordx4 v18, s[40:43], s76 offen offset:2048 lds
    buffer_load_dwordx4 v19, s[40:43], s76 offen offset:3072 lds
    s_add_u32 s39, s39, 1
    s_cmp_eq_u32 s39, 10
    s_cselect_b32 s39, 0, s39
    s_mov_b64 exec, 0
    s_cmp_eq_u32 s34, 0
    s_cbranch_scc1 PADG0
    s_cmp_eq_u32 s34, 1
    s_cbranch_scc1 PADG1
    s_cmp_eq_u32 s34, 2
    s_cbranch_scc1 PADG2
    s_cmp_eq_u32 s34, 3
    s_cbranch_scc1 PADG3
WR44:
    s_mov_b64 exec, -1
    s_add_u32 m0, s67, 32768
    s_lshl_b32 s76, s39, 7
    s_nop 0
    buffer_load_dwordx4 v16, s[40:43], s76 offen offset:0 lds
    buffer_load_dwordx4 v17, s[40:43], s76 offen offset:1024 lds
    buffer_load_dwordx4 v18, s[40:43], s76 offen offset:2048 lds
    buffer_load_dwordx4 v19, s[40:43], s76 offen offset:3072 lds
    s_add_u32 m0, s67, 98304
    s_mul_i32 s77, s39, 196608
    buffer_load_dwordx4 v20, s[44:47], s77 offen offset:0 lds
PADG0:
    s_cbranch_execz WR44
    buffer_load_dwordx4 v21, s[44:47], s77 offen offset:1024 lds
    buffer_load_dwordx4 v22, s[44:47], s77 offen offset:2048 lds
    buffer_load_dwordx4 v23, s[44:47], s77 offen offset:3072 lds
    s_add_u32 s39, s39, 1
    s_cmp_eq_u32 s39, 10
    s_cselect_b32 s39, 0, s39
    s_waitcnt vmcnt(17) lgkmcnt(0)
    s_barrier
    ds_read_b64_tr_b16 v[96:97], v26 offset:0
    ds_read_b64_tr_b16 v[98:99], v26 offset:1024
    ds_read_b64_tr_b16 v[100:101], v26 offset:8192
    ds_read_b64_tr_b16 v[102:103], v26 offset:9216
    ds_read_b128 v[32:35], v24 offset:0
    ds_read_b128 v[36:39], v25 offset:0
    ds_read_b128 v[40:43], v24 offset:2048
    ds_read_b128 v[44:47], v25 offset:2048
    ds_read_b128 v[48:51], v24 offset:4096
    ds_read_b128 v[52:55], v25 offset:4096
    ds_read_b128 v[56:59], v24 offset:6144
    ds_read_b128 v[60:63], v25 offset:6144
    ds_read_b64_tr_b16 v[104:105], v27 offset:0
    ds_read_b64_tr_b16 v[106:107], v27 offset:1024
    ds_read_b64_tr_b16 v[108:109], v27 offset:8192
    ds_read_b64_tr_b16 v[110:111], v27 offset:9216
    s_mul_i32 s21, s21, 0x9e3779b1
    s_add_u32 s21, s21, 0x7f4a7c15
    s_waitcnt lgkmcnt(0)
    s_nop 0
    v_mfma_f32_16x16x32_bf16 v[144:147], v[96:99], v[32:35], 0
    ds_read_b64_tr_b16 v[112:113], v28 offset:0
    v_mfma_f32_16x16x32_bf16 v[144:147], v[100:103], v[36:39], v[144:147]
    ds_read_b64_tr_b16 v[114:115], v28 offset:1024
    v_mfma_f32_16x16x32_bf16 v[152:155], v[96:99], v[40:43], 0
    ds_read_b64_tr_b16 v[116:117], v28 offset:8192
    v_mfma_f32_16x16x32_bf16 v[152:155], v[100:103], v[44:47], v[152:155]
    ds_read_b64_tr_b16 v[118:119], v28 offset:9216
    v_mfma_f32_16x16x32_bf16 v[160:163], v[96:99], v[48:51], 0
    ds_read_b64_tr_b16 v[120:121], v29 offset:0
    v_mfma_f32_16x16x32_bf16 v[160:163], v[100:103], v[52:55], v[160:163]
    ds_read_b64_tr_b16 v[122:123], v29 offset:1024
    v_mfma_f32_16x16x32_bf16 v[168:171], v[96:99], v[56:59], 0
    ds_read_b64_tr_b16 v[124:125], v29 offset:8192
    v_mfma_f32_16x16x32_bf16 v[168:171], v[100:103], v[60:63], v[168:171]
    ds_read_b64_tr_b16 v[126:127], v29 offset:9216
    v_mfma_f32_16x16x32_bf16 v[148:151], v[104:107], v[32:35], 0
    s_add_u32 m0, s67, 49152
    s_lshl_b32 s76, s39, 7
    s_nop 0
    buffer_load_dwordx4 v16, s[40:43], s76 offen offset:0 lds
    v_mfma_f32_16x16x32_bf16 v[148:151], v[108:111], v[36:39], v[148:151]
    buffer_load_dwordx4 v17, s[40:43], s76 offen offset:1024 lds
    v_mfma_f32_16x16x32_bf16 v[156:159], v[104:107], v[40:43], 0
    buffer_load_dwordx4 v18, s[40:43], s76 offen offset:2048 lds
    v_mfma_f32_16x16x32_bf16 v[156:159], v[108:111], v[44:47], v[156:159]
    buffer_load_dwordx4 v19, s[40:43], s76 offen offset:3072 lds
    v_mfma_f32_16x16x32_bf16 v[164:167], v[104:107], v[48:51], 0
    s_add_u32 m0, s67, 114688
    s_mul_i32 s77, s39, 196608
    buffer_load_dwordx4 v20, s[44:47], s77 offen offset:0 lds
    v_mfma_f32_16x16x32_bf16 v[164:167], v[108:111], v[52:55], v[164:167]
    buffer_load_dwordx4 v21, s[44:47], s77 offen offset:1024 lds
    v_mfma_f32_16x16x32_bf16 v[172:175], v[104:107], v[56:59], 0
    buffer_load_dwordx4 v22, s[44:47], s77 offen offset:2048 lds
    v_mfma_f32_16x16x32_bf16 v[172:175], v[108:111], v[60:63], v[172:175]
    buffer_load_dwordx4 v23, s[44:47], s77 offen offset:3072 lds
    s_add_u32 s39, s39, 1
    s_cmp_eq_u32 s39, 10
    s_cselect_b32 s39, 0, s39
    s_waitcnt vmcnt(16) lgkmcnt(0)
    s_barrier
    s_nop 0
    v_mfma_f32_16x16x32_bf16 v[176:179], v[112:115], v[32:35], 0
    ds_read_b64_tr_b16 v[96:97], v26 offset:16384
    ds_read_b64_tr_b16 v[98:99], v26 offset:17408
    v_mfma_f32_16x16x32_bf16 v[176:179], v[116:119], v[36:39], v[176:179]
    ds_read_b64_tr_b16 v[100:101], v26 offset:24576
    ds_read_b64_tr_b16 v[102:103], v26 offset:25600
    v_mfma_f32_16x16x32_bf16 v[184:187], v[112:115], v[40:43], 0
    ds_read_b128 v[64:67], v24 offset:16384
    ds_read_b128 v[68:71], v25 offset:16384
    v_mfma_f32_16x16x32_bf16 v[184:187], v[116:119], v[44:47], v[184:187]
    ds_read_b128 v[72:75], v24 offset:18432
    ds_read_b128 v[76:79], v25 offset:18432
    v_mfma_f32_16x16x32_bf16 v[192:195], v[112:115], v[48:51], 0
    ds_read_b128 v[80:83], v24 offset:20480
    ds_read_b128 v[84:87], v25 offset:20480
    v_mfma_f32_16x16x32_bf16 v[192:195], v[116:119], v[52:55], v[192:195]
    ds_read_b128 v[88:91], v24 offset:22528
    ds_read_b128 v[92:95], v25 offset:22528
    v_mfma_f32_16x16x32_bf16 v[200:203], v[112:115], v[56:59], 0
    ds_read_b64_tr_b16 v[104:105], v27 offset:16384
    v_mfma_f32_16x16x32_bf16 v[200:203], v[116:119], v[60:63], v[200:203]
    ds_read_b64_tr_b16 v[106:107], v27 offset:17408
    v_mfma_f32_16x16x32_bf16 v[180:183], v[120:123], v[32:35], 0
    ds_read_b64_tr_b16 v[108:109], v27 offset:24576
    v_mfma_f32_16x16x32_bf16 v[180:183], v[124:127], v[36:39], v[180:183]
    ds_read_b64_tr_b16 v[110:111], v27 offset:25600
    v_mfma_f32_16x16x32_bf16 v[188:191], v[120:123], v[40:43], 0
    s_add_u32 m0, s67, 0
    s_lshl_b32 s76, s39, 7
    buffer_load_dwordx4 v16, s[40:43], s76 offen offset:0 lds
    v_mfma_f32_16x16x32_bf16 v[188:191], v[124:127], v[44:47], v[188:191]
    buffer_load_dwordx4 v17, s[40:43], s76 offen offset:1024 lds
    v_mfma_f32_16x16x32_bf16 v[196:199], v[120:123], v[48:51], 0
    buffer_load_dwordx4 v18, s[40:43], s76 offen offset:2048 lds
    v_mfma_f32_16x16x32_bf16 v[196:199], v[124:127], v[52:55], v[196:199]
    buffer_load_dwordx4 v19, s[40:43], s76 offen offset:3072 lds
    v_mfma_f32_16x16x32_bf16 v[204:207], v[120:123], v[56:59], 0
    v_mfma_f32_16x16x32_bf16 v[204:207], v[124:127], v[60:63], v[204:207]
    s_waitcnt lgkmcnt(0)
    s_nop 0
    v_mfma_f32_16x16x32_bf16 v[144:147], v[96:99], v[64:67], v[144:147]
    ds_read_b64_tr_b16 v[112:113], v28 offset:16384
    v_mfma_f32_16x16x32_bf16 v[144:147], v[100:103], v[68:71], v[144:147]
    s_add_u32 m0, s67, 65536
    s_mul_i32 s77, s39, 196608
    buffer_load_dwordx4 v20, s[44:47], s77 offen offset:0 lds
    v_mfma_f32_16x16x32_bf16 v[152:155], v[96:99], v[72:75], v[152:155]
    ds_read_b64_tr_b16 v[114:115], v28 offset:17408
    v_mfma_f32_16x16x32_bf16 v[152:155], v[100:103], v[76:79], v[152:155]
    ds_read_b64_tr_b16 v[116:117], v28 offset:24576
    v_mfma_f32_16x16x32_bf16 v[160:163], v[96:99], v[80:83], v[160:163]
    buffer_load_dwordx4 v21, s[44:47], s77 offen offset:1024 lds
    v_mfma_f32_16x16x32_bf16 v[160:163], v[100:103], v[84:87], v[160:163]
    ds_read_b64_tr_b16 v[118:119], v28 offset:25600
    v_mfma_f32_16x16x32_bf16 v[168:171], v[96:99], v[88:91], v[168:171]
    ds_read_b64_tr_b16 v[120:121], v29 offset:16384
    v_mfma_f32_16x16x32_bf16 v[168:171], v[100:103], v[92:95], v[168:171]
    buffer_load_dwordx4 v22, s[44:47], s77 offen offset:2048 lds
    v_mfma_f32_16x16x32_bf16 v[148:151], v[104:107], v[64:67], v[148:151]
    ds_read_b64_tr_b16 v[122:123], v29 offset:17408
    v_mfma_f32_16x16x32_bf16 v[148:151], v[108:111], v[68:71], v[148:151]
    ds_read_b64_tr_b16 v[124:125], v29 offset:24576
    v_mfma_f32_16x16x32_bf16 v[156:159], v[104:107], v[72:75], v[156:159]
    buffer_load_dwordx4 v23, s[44:47], s77 offen offset:3072 lds
    s_add_u32 s39, s39, 1
    s_cmp_eq_u32 s39, 10
    s_cselect_b32 s39, 0, s39
    v_mfma_f32_16x16x32_bf16 v[156:159], v[108:111], v[76:79], v[156:159]
    ds_read_b64_tr_b16 v[126:127], v29 offset:25600
    v_mfma_f32_16x16x32_bf16 v[164:167], v[104:107], v[80:83], v[164:167]
    v_mfma_f32_16x16x32_bf16 v[164:167], v[108:111], v[84:87], v[164:167]
    v_mfma_f32_16x16x32_bf16 v[172:175], v[104:107], v[88:91], v[172:175]
    v_mfma_f32_16x16x32_bf16 v[172:175], v[108:111], v[92:95], v[172:175]
    s_waitcnt vmcnt(16) lgkmcnt(0)
    s_barrier
    s_nop 0
    v_mfma_f32_16x16x32_bf16 v[176:179], v[112:115], v[64:67], v[176:179]
    ds_read_b64_tr_b16 v[96:97], v26 offset:32768
    ds_read_b64_tr_b16 v[98:99], v26 offset:33792
    v_mfma_f32_16x16x32_bf16 v[176:179], v[116:119], v[68:71], v[176:179]
    ds_read_b64_tr_b16 v[100:101], v26 offset:40960
    ds_read_b64_tr_b16 v[102:103], v26 offset:41984
    v_mfma_f32_16x16x32_bf16 v[184:187], v[112:115], v[72:75], v[184:187]
    ds_read_b128 v[32:35], v24 offset:32768
    ds_read_b128 v[36:39], v25 offset:32768
    v_mfma_f32_16x16x32_bf16 v[184:187], v[116:119], v[76:79], v[184:187]
    ds_read_b128 v[40:43], v24 offset:34816
    ds_read_b128 v[44:47], v25 offset:34816
    v_mfma_f32_16x16x32_bf16 v[192:195], v[112:115], v[80:83], v[192:195]
    ds_read_b128 v[48:51], v24 offset:36864
    ds_read_b128 v[52:55], v25 offset:36864
    v_mfma_f32_16x16x32_bf16 v[192:195], v[116:119], v[84:87], v[192:195]
    ds_read_b128 v[56:59], v24 offset:38912
    v_mfma_f32_16x16x32_bf16 v[200:203], v[112:115], v[88:91], v[200:203]
    ds_read_b128 v[60:63], v25 offset:38912
    v_mfma_f32_16x16x32_bf16 v[200:203], v[116:119], v[92:95], v[200:203]
    ds_read_b64_tr_b16 v[104:105], v27 offset:32768
    v_mfma_f32_16x16x32_bf16 v[180:183], v[120:123], v[64:67], v[180:183]
    ds_read_b64_tr_b16 v[106:107], v27 offset:33792
    v_mfma_f32_16x16x32_bf16 v[180:183], v[124:127], v[68:71], v[180:183]
    ds_read_b64_tr_b16 v[108:109], v27 offset:40960
    v_mfma_f32_16x16x32_bf16 v[188:191], v[120:123], v[72:75], v[188:191]
    ds_read_b64_tr_b16 v[110:111], v27 offset:41984
    v_mfma_f32_16x16x32_bf16 v[188:191], v[124:127], v[76:79], v[188:191]
    v_mfma_f32_16x16x32_bf16 v[196:199], v[120:123], v[80:83], v[196:199]
    v_mfma_f32_16x16x32_bf16 v[196:199], v[124:127], v[84:87], v[196:199]
    v_mfma_f32_16x16x32_bf16 v[204:207], v[120:123], v[88:91], v[204:207]
    v_mfma_f32_16x16x32_bf16 v[204:207], v[124:127], v[92:95], v[204:207]
    s_waitcnt lgkmcnt(0)
    s_nop 0
    v_mfma_f32_16x16x32_bf16 v[144:147], v[96:99], v[32:35], v[144:147]
    ds_read_b64_tr_b16 v[112:113], v28 offset:32768
    v_mfma_f32_16x16x32_bf16 v[144:147], v[100:103], v[36:39], v[144:147]
    ds_read_b64_tr_b16 v[114:115], v28 offset:33792
    v_mfma_f32_16x16x32_bf16 v[152:155], v[96:99], v[40:43], v[152:155]
    ds_read_b64_tr_b16 v[116:117], v28 offset:40960
    v_mfma_f32_16x16x32_bf16 v[152:155], v[100:103], v[44:47], v[152:155]
    ds_read_b64_tr_b16 v[118:119], v28 offset:41984
    v_mfma_f32_16x16x32_bf16 v[160:163], v[96:99], v[48:51], v[160:163]
    ds_read_b64_tr_b16 v[120:121], v29 offset:32768
    v_mfma_f32_16x16x32_bf16 v[160:163], v[100:103], v[52:55], v[160:163]
    ds_read_b64_tr_b16 v[122:123], v29 offset:33792
    v_mfma_f32_16x16x32_bf16 v[168:171], v[96:99], v[56:59], v[168:171]
    ds_read_b64_tr_b16 v[124:125], v29 offset:40960
    v_mfma_f32_16x16x32_bf16 v[168:171], v[100:103], v[60:63], v[168:171]
    ds_read_b64_tr_b16 v[126:127], v29 offset:41984
    v_mfma_f32_16x16x32_bf16 v[148:151], v[104:107], v[32:35], v[148:151]
    v_mfma_f32_16x16x32_bf16 v[148:151], v[108:111], v[36:39], v[148:151]
    v_mfma_f32_16x16x32_bf16 v[156:159], v[104:107], v[40:43], v[156:159]
    v_mfma_f32_16x16x32_bf16 v[156:159], v[108:111], v[44:47], v[156:159]
    v_mfma_f32_16x16x32_bf16 v[164:167], v[104:107], v[48:51], v[164:167]
    v_mfma_f32_16x16x32_bf16 v[164:167], v[108:111], v[52:55], v[164:167]
    v_mfma_f32_16x16x32_bf16 v[172:175], v[104:107], v[56:59], v[172:175]
    v_mfma_f32_16x16x32_bf16 v[172:175], v[108:111], v[60:63], v[172:175]
    s_waitcnt vmcnt(8) lgkmcnt(0)
    s_barrier
    v_mfma_f32_16x16x32_bf16 v[176:179], v[112:115], v[32:35], v[176:179]
    ds_read_b64_tr_b16 v[96:97], v26 offset:49152
    ds_read_b64_tr_b16 v[98:99], v26 offset:50176
    v_mfma_f32_16x16x32_bf16 v[176:179], v[116:119], v[36:39], v[176:179]
    ds_read_b64_tr_b16 v[100:101], v26 offset:57344
    ds_read_b64_tr_b16 v[102:103], v26 offset:58368
    v_mfma_f32_16x16x32_bf16 v[184:187], v[112:115], v[40:43], v[184:187]
    ds_read_b128 v[64:67], v24 offset:49152
    ds_read_b128 v[68:71], v25 offset:49152
    v_mfma_f32_16x16x32_bf16 v[184:187], v[116:119], v[44:47], v[184:187]
    ds_read_b128 v[72:75], v24 offset:51200
    ds_read_b128 v[76:79], v25 offset:51200
    v_mfma_f32_16x16x32_bf16 v[192:195], v[112:115], v[48:51], v[192:195]
    ds_read_b128 v[80:83], v24 offset:53248
    ds_read_b128 v[84:87], v25 offset:53248
    v_mfma_f32_16x16x32_bf16 v[192:195], v[116:119], v[52:55], v[192:195]
    ds_read_b128 v[88:91], v24 offset:55296
    v_mfma_f32_16x16x32_bf16 v[200:203], v[112:115], v[56:59], v[200:203]
    ds_read_b128 v[92:95], v25 offset:55296
    v_mfma_f32_16x16x32_bf16 v[200:203], v[116:119], v[60:63], v[200:203]
    ds_read_b64_tr_b16 v[104:105], v27 offset:49152
    v_mfma_f32_16x16x32_bf16 v[180:183], v[120:123], v[32:35], v[180:183]
    ds_read_b64_tr_b16 v[106:107], v27 offset:50176
    v_mfma_f32_16x16x32_bf16 v[180:183], v[124:127], v[36:39], v[180:183]
    ds_read_b64_tr_b16 v[108:109], v27 offset:57344
    v_mfma_f32_16x16x32_bf16 v[188:191], v[120:123], v[40:43], v[188:191]
    ds_read_b64_tr_b16 v[110:111], v27 offset:58368
    v_mfma_f32_16x16x32_bf16 v[188:191], v[124:127], v[44:47], v[188:191]
    v_mfma_f32_16x16x32_bf16 v[196:199], v[120:123], v[48:51], v[196:199]
    v_mfma_f32_16x16x32_bf16 v[196:199], v[124:127], v[52:55], v[196:199]
    v_mfma_f32_16x16x32_bf16 v[204:207], v[120:123], v[56:59], v[204:207]
    v_mfma_f32_16x16x32_bf16 v[204:207], v[124:127], v[60:63], v[204:207]
    s_waitcnt lgkmcnt(0)
    s_nop 0
    v_mfma_f32_16x16x32_bf16 v[144:147], v[96:99], v[64:67], v[144:147]
    ds_read_b64_tr_b16 v[112:113], v28 offset:49152
    v_mfma_f32_16x16x32_bf16 v[144:147], v[100:103], v[68:71], v[144:147]
    ds_read_b64_tr_b16 v[114:115], v28 offset:50176
    v_mfma_f32_16x16x32_bf16 v[152:155], v[96:99], v[72:75], v[152:155]
    ds_read_b64_tr_b16 v[116:117], v28 offset:57344
    v_mfma_f32_16x16x32_bf16 v[152:155], v[100:103], v[76:79], v[152:155]
    ds_read_b64_tr_b16 v[118:119], v28 offset:58368
    v_mfma_f32_16x16x32_bf16 v[160:163], v[96:99], v[80:83], v[160:163]
    ds_read_b64_tr_b16 v[120:121], v29 offset:49152
    v_mfma_f32_16x16x32_bf16 v[160:163], v[100:103], v[84:87], v[160:163]
    ds_read_b64_tr_b16 v[122:123], v29 offset:50176
    v_mfma_f32_16x16x32_bf16 v[168:171], v[96:99], v[88:91], v[168:171]
    ds_read_b64_tr_b16 v[124:125], v29 offset:57344
    v_mfma_f32_16x16x32_bf16 v[168:171], v[100:103], v[92:95], v[168:171]
    ds_read_b64_tr_b16 v[126:127], v29 offset:58368
    v_mfma_f32_16x16x32_bf16 v[148:151], v[104:107], v[64:67], v[148:151]
    v_mfma_f32_16x16x32_bf16 v[148:151], v[108:111], v[68:71], v[148:151]
    v_mfma_f32_16x16x32_bf16 v[156:159], v[104:107], v[72:75], v[156:159]
    v_mfma_f32_16x16x32_bf16 v[156:159], v[108:111], v[76:79], v[156:159]
    v_mfma_f32_16x16x32_bf16 v[164:167], v[104:107], v[80:83], v[164:167]
    v_mfma_f32_16x16x32_bf16 v[164:167], v[108:111], v[84:87], v[164:167]
    v_mfma_f32_16x16x32_bf16 v[172:175], v[104:107], v[88:91], v[172:175]
    v_mfma_f32_16x16x32_bf16 v[172:175], v[108:111], v[92:95], v[172:175]
    s_waitcnt vmcnt(0) lgkmcnt(0)
    s_barrier
    v_mfma_f32_16x16x32_bf16 v[176:179], v[112:115], v[64:67], v[176:179]
    ds_read_b64_tr_b16 v[96:97], v26 offset:0
    ds_read_b64_tr_b16 v[98:99], v26 offset:1024
    v_mfma_f32_16x16x32_bf16 v[176:179], v[116:119], v[68:71], v[176:179]
    ds_read_b64_tr_b16 v[100:101], v26 offset:8192
    ds_read_b64_tr_b16 v[102:103], v26 offset:9216
    v_mfma_f32_16x16x32_bf16 v[184:187], v[112:115], v[72:75], v[184:187]
    ds_read_b128 v[32:35], v24 offset:0
    ds_read_b128 v[36:39], v25 offset:0
    v_mfma_f32_16x16x32_bf16 v[184:187], v[116:119], v[76:79], v[184:187]
    ds_read_b128 v[40:43], v24 offset:2048
    ds_read_b128 v[44:47], v25 offset:2048
    v_mfma_f32_16x16x32_bf16 v[192:195], v[112:115], v[80:83], v[192:195]
    ds_read_b128 v[48:51], v24 offset:4096
    ds_read_b128 v[52:55], v25 offset:4096
    v_mfma_f32_16x16x32_bf16 v[192:195], v[116:119], v[84:87], v[192:195]
    ds_read_b128 v[56:59], v24 offset:6144
    v_mfma_f32_16x16x32_bf16 v[200:203], v[112:115], v[88:91], v[200:203]
    ds_read_b128 v[60:63], v25 offset:6144
    v_mfma_f32_16x16x32_bf16 v[200:203], v[116:119], v[92:95], v[200:203]
    ds_read_b64_tr_b16 v[104:105], v27 offset:0
    v_mfma_f32_16x16x32_bf16 v[180:183], v[120:123], v[64:67], v[180:183]
    ds_read_b64_tr_b16 v[106:107], v27 offset:1024
    v_mfma_f32_16x16x32_bf16 v[180:183], v[124:127], v[68:71], v[180:183]
    ds_read_b64_tr_b16 v[108:109], v27 offset:8192
    v_mfma_f32_16x16x32_bf16 v[188:191], v[120:123], v[72:75], v[188:191]
    ds_read_b64_tr_b16 v[110:111], v27 offset:9216
    v_mfma_f32_16x16x32_bf16 v[188:191], v[124:127], v[76:79], v[188:191]
    v_mfma_f32_16x16x32_bf16 v[196:199], v[120:123], v[80:83], v[196:199]
    v_mfma_f32_16x16x32_bf16 v[196:199], v[124:127], v[84:87], v[196:199]
    v_mfma_f32_16x16x32_bf16 v[204:207], v[120:123], v[88:91], v[204:207]
    v_mfma_f32_16x16x32_bf16 v[204:207], v[124:127], v[92:95], v[204:207]
    s_waitcnt lgkmcnt(0)
    s_nop 0
    v_mfma_f32_16x16x32_bf16 v[144:147], v[96:99], v[32:35], v[144:147]
    ds_read_b64_tr_b16 v[112:113], v28 offset:0
    v_mfma_f32_16x16x32_bf16 v[144:147], v[100:103], v[36:39], v[144:147]
    ds_read_b64_tr_b16 v[114:115], v28 offset:1024
    v_mfma_f32_16x16x32_bf16 v[152:155], v[96:99], v[40:43], v[152:155]
    ds_read_b64_tr_b16 v[116:117], v28 offset:8192
    v_mfma_f32_16x16x32_bf16 v[152:155], v[100:103], v[44:47], v[152:155]
    ds_read_b64_tr_b16 v[118:119], v28 offset:9216
    v_mfma_f32_16x16x32_bf16 v[160:163], v[96:99], v[48:51], v[160:163]
    ds_read_b64_tr_b16 v[120:121], v29 offset:0
    v_mfma_f32_16x16x32_bf16 v[160:163], v[100:103], v[52:55], v[160:163]
    ds_read_b64_tr_b16 v[122:123], v29 offset:1024
    v_mfma_f32_16x16x32_bf16 v[168:171], v[96:99], v[56:59], v[168:171]
    ds_read_b64_tr_b16 v[124:125], v29 offset:8192
    v_mfma_f32_16x16x32_bf16 v[168:171], v[100:103], v[60:63], v[168:171]
    ds_read_b64_tr_b16 v[126:127], v29 offset:9216
    v_mfma_f32_16x16x32_bf16 v[148:151], v[104:107], v[32:35], v[148:151]
    v_mfma_f32_16x16x32_bf16 v[148:151], v[108:111], v[36:39], v[148:151]
    v_mfma_f32_16x16x32_bf16 v[156:159], v[104:107], v[40:43], v[156:159]
    v_mfma_f32_16x16x32_bf16 v[156:159], v[108:111], v[44:47], v[156:159]
    v_mfma_f32_16x16x32_bf16 v[164:167], v[104:107], v[48:51], v[164:167]
    v_mfma_f32_16x16x32_bf16 v[164:167], v[108:111], v[52:55], v[164:167]
    v_mfma_f32_16x16x32_bf16 v[172:175], v[104:107], v[56:59], v[172:175]
    v_mfma_f32_16x16x32_bf16 v[172:175], v[108:111], v[60:63], v[172:175]
    s_waitcnt lgkmcnt(0)
    s_barrier
    v_mfma_f32_16x16x32_bf16 v[176:179], v[112:115], v[32:35], v[176:179]
    ds_read_b64_tr_b16 v[96:97], v26 offset:16384
    ds_read_b64_tr_b16 v[98:99], v26 offset:17408
    v_mfma_f32_16x16x32_bf16 v[176:179], v[116:119], v[36:39], v[176:179]
    ds_read_b64_tr_b16 v[100:101], v26 offset:24576
    ds_read_b64_tr_b16 v[102:103], v26 offset:25600
    v_mfma_f32_16x16x32_bf16 v[184:187], v[112:115], v[40:43], v[184:187]
    ds_read_b128 v[64:67], v24 offset:16384
    ds_read_b128 v[68:71], v25 offset:16384
    v_mfma_f32_16x16x32_bf16 v[184:187], v[116:119], v[44:47], v[184:187]
    ds_read_b128 v[72:75], v24 offset:18432
    ds_read_b128 v[76:79], v25 offset:18432
    v_mfma_f32_16x16x32_bf16 v[192:195], v[112:115], v[48:51], v[192:195]
    ds_read_b128 v[80:83], v24 offset:20480
    ds_read_b128 v[84:87], v25 offset:20480
    v_mfma_f32_16x16x32_bf16 v[192:195], v[116:119], v[52:55], v[192:195]
    ds_read_b128 v[88:91], v24 offset:22528
    v_mfma_f32_16x16x32_bf16 v[200:203], v[112:115], v[56:59], v[200:203]
    ds_read_b128 v[92:95], v25 offset:22528
    v_mfma_f32_16x16x32_bf16 v[200:203], v[116:119], v[60:63], v[200:203]
    ds_read_b64_tr_b16 v[104:105], v27 offset:16384
    v_mfma_f32_16x16x32_bf16 v[180:183], v[120:123], v[32:35], v[180:183]
    ds_read_b64_tr_b16 v[106:107], v27 offset:17408
    v_mfma_f32_16x16x32_bf16 v[180:183], v[124:127], v[36:39], v[180:183]
    ds_read_b64_tr_b16 v[108:109], v27 offset:24576
    v_mfma_f32_16x16x32_bf16 v[188:191], v[120:123], v[40:43], v[188:191]
    ds_read_b64_tr_b16 v[110:111], v27 offset:25600
    v_mfma_f32_16x16x32_bf16 v[188:191], v[124:127], v[44:47], v[188:191]
    v_mfma_f32_16x16x32_bf16 v[196:199], v[120:123], v[48:51], v[196:199]
    v_mfma_f32_16x16x32_bf16 v[196:199], v[124:127], v[52:55], v[196:199]
    v_mfma_f32_16x16x32_bf16 v[204:207], v[120:123], v[56:59], v[204:207]
    v_mfma_f32_16x16x32_bf16 v[204:207], v[124:127], v[60:63], v[204:207]
    s_waitcnt lgkmcnt(0)
    s_nop 0
    v_mfma_f32_16x16x32_bf16 v[144:147], v[96:99], v[64:67], v[144:147]
    ds_read_b64_tr_b16 v[112:113], v28 offset:16384
    v_mfma_f32_16x16x32_bf16 v[144:147], v[100:103], v[68:71], v[144:147]
    ds_read_b64_tr_b16 v[114:115], v28 offset:17408
    v_mfma_f32_16x16x32_bf16 v[152:155], v[96:99], v[72:75], v[152:155]
    ds_read_b64_tr_b16 v[116:117], v28 offset:24576
    v_mfma_f32_16x16x32_bf16 v[152:155], v[100:103], v[76:79], v[152:155]
    ds_read_b64_tr_b16 v[118:119], v28 offset:25600
    v_mfma_f32_16x16x32_bf16 v[160:163], v[96:99], v[80:83], v[160:163]
    ds_read_b64_tr_b16 v[120:121], v29 offset:16384
    v_mfma_f32_16x16x32_bf16 v[160:163], v[100:103], v[84:87], v[160:163]
    ds_read_b64_tr_b16 v[122:123], v29 offset:17408
    v_mfma_f32_16x16x32_bf16 v[168:171], v[96:99], v[88:91], v[168:171]
    ds_read_b64_tr_b16 v[124:125], v29 offset:24576
    v_mfma_f32_16x16x32_bf16 v[168:171], v[100:103], v[92:95], v[168:171]
    ds_read_b64_tr_b16 v[126:127], v29 offset:25600
    v_mfma_f32_16x16x32_bf16 v[148:151], v[104:107], v[64:67], v[148:151]
    v_add_u32 v16, 0xffff0000, v4
    v_mfma_f32_16x16x32_bf16 v[148:151], v[108:111], v[68:71], v[148:151]
    v_add_u32 v17, 0xffff0000, v5
    v_mfma_f32_16x16x32_bf16 v[156:159], v[104:107], v[72:75], v[156:159]
    v_add_u32 v18, 0xffff0000, v6
    v_mfma_f32_16x16x32_bf16 v[156:159], v[108:111], v[76:79], v[156:159]
    v_add_u32 v19, 0xffff0000, v7
    v_mfma_f32_16x16x32_bf16 v[164:167], v[104:107], v[80:83], v[164:167]
    v_mfma_f32_16x16x32_bf16 v[164:167], v[108:111], v[84:87], v[164:167]
    v_mfma_f32_16x16x32_bf16 v[172:175], v[104:107], v[88:91], v[172:175]
    v_mfma_f32_16x16x32_bf16 v[172:175], v[108:111], v[92:95], v[172:175]
    s_waitcnt lgkmcnt(0)
    s_barrier
    v_mfma_f32_16x16x32_bf16 v[176:179], v[112:115], v[64:67], v[176:179]
    ds_read_b64_tr_b16 v[96:97], v26 offset:32768
    ds_read_b64_tr_b16 v[98:99], v26 offset:33792
    v_mfma_f32_16x16x32_bf16 v[176:179], v[116:119], v[68:71], v[176:179]
    ds_read_b64_tr_b16 v[100:101], v26 offset:40960
    ds_read_b64_tr_b16 v[102:103], v26 offset:41984
    v_mfma_f32_16x16x32_bf16 v[184:187], v[112:115], v[72:75], v[184:187]
    ds_read_b128 v[32:35], v24 offset:32768
    ds_read_b128 v[36:39], v25 offset:32768
    v_mfma_f32_16x16x32_bf16 v[184:187], v[116:119], v[76:79], v[184:187]
    ds_read_b128 v[40:43], v24 offset:34816
    ds_read_b128 v[44:47], v25 offset:34816
    v_mfma_f32_16x16x32_bf16 v[192:195], v[112:115], v[80:83], v[192:195]
    ds_read_b128 v[48:51], v24 offset:36864
    ds_read_b128 v[52:55], v25 offset:36864
    v_mfma_f32_16x16x32_bf16 v[192:195], v[116:119], v[84:87], v[192:195]
    ds_read_b128 v[56:59], v24 offset:38912
    v_mfma_f32_16x16x32_bf16 v[200:203], v[112:115], v[88:91], v[200:203]
    ds_read_b128 v[60:63], v25 offset:38912
    v_mfma_f32_16x16x32_bf16 v[200:203], v[116:119], v[92:95], v[200:203]
    ds_read_b64_tr_b16 v[104:105], v27 offset:32768
    v_mfma_f32_16x16x32_bf16 v[180:183], v[120:123], v[64:67], v[180:183]
    ds_read_b64_tr_b16 v[106:107], v27 offset:33792
    v_mfma_f32_16x16x32_bf16 v[180:183], v[124:127], v[68:71], v[180:183]
    ds_read_b64_tr_b16 v[108:109], v27 offset:40960
    v_mfma_f32_16x16x32_bf16 v[188:191], v[120:123], v[72:75], v[188:191]
    ds_read_b64_tr_b16 v[110:111], v27 offset:41984
    v_mfma_f32_16x16x32_bf16 v[188:191], v[124:127], v[76:79], v[188:191]
    v_mfma_f32_16x16x32_bf16 v[196:199], v[120:123], v[80:83], v[196:199]
    v_mfma_f32_16x16x32_bf16 v[196:199], v[124:127], v[84:87], v[196:199]
    v_mfma_f32_16x16x32_bf16 v[204:207], v[120:123], v[88:91], v[204:207]
    v_mfma_f32_16x16x32_bf16 v[204:207], v[124:127], v[92:95], v[204:207]
    s_waitcnt lgkmcnt(0)
    s_nop 0
    v_mfma_f32_16x16x32_bf16 v[144:147], v[96:99], v[32:35], v[144:147]
    ds_read_b64_tr_b16 v[112:113], v28 offset:32768
    v_mfma_f32_16x16x32_bf16 v[144:147], v[100:103], v[36:39], v[144:147]
    ds_read_b64_tr_b16 v[114:115], v28 offset:33792
    v_mfma_f32_16x16x32_bf16 v[152:155], v[96:99], v[40:43], v[152:155]
    ds_read_b64_tr_b16 v[116:117], v28 offset:40960
    v_mfma_f32_16x16x32_bf16 v[152:155], v[100:103], v[44:47], v[152:155]
    ds_read_b64_tr_b16 v[118:119], v28 offset:41984
    v_mfma_f32_16x16x32_bf16 v[160:163], v[96:99], v[48:51], v[160:163]
    ds_read_b64_tr_b16 v[120:121], v29 offset:32768
    v_mfma_f32_16x16x32_bf16 v[160:163], v[100:103], v[52:55], v[160:163]
    ds_read_b64_tr_b16 v[122:123], v29 offset:33792
    v_mfma_f32_16x16x32_bf16 v[168:171], v[96:99], v[56:59], v[168:171]
    ds_read_b64_tr_b16 v[124:125], v29 offset:40960
    v_mfma_f32_16x16x32_bf16 v[168:171], v[100:103], v[60:63], v[168:171]
    ds_read_b64_tr_b16 v[126:127], v29 offset:41984
    v_mfma_f32_16x16x32_bf16 v[148:151], v[104:107], v[32:35], v[148:151]
    v_mfma_f32_16x16x32_bf16 v[148:151], v[108:111], v[36:39], v[148:151]
    v_mfma_f32_16x16x32_bf16 v[156:159], v[104:107], v[40:43], v[156:159]
    v_mfma_f32_16x16x32_bf16 v[156:159], v[108:111], v[44:47], v[156:159]
    v_mfma_f32_16x16x32_bf16 v[164:167], v[104:107], v[48:51], v[164:167]
    v_mfma_f32_16x16x32_bf16 v[164:167], v[108:111], v[52:55], v[164:167]
    v_mfma_f32_16x16x32_bf16 v[172:175], v[104:107], v[56:59], v[172:175]
    v_mfma_f32_16x16x32_bf16 v[172:175], v[108:111], v[60:63], v[172:175]
    s_waitcnt lgkmcnt(0)
    s_barrier
    v_mfma_f32_16x16x32_bf16 v[176:179], v[112:115], v[32:35], v[176:179]
    ds_read_b64_tr_b16 v[96:97], v26 offset:49152
    ds_read_b64_tr_b16 v[98:99], v26 offset:50176
    v_mfma_f32_16x16x32_bf16 v[176:179], v[116:119], v[36:39], v[176:179]
    ds_read_b64_tr_b16 v[100:101], v26 offset:57344
    ds_read_b64_tr_b16 v[102:103], v26 offset:58368
    v_mfma_f32_16x16x32_bf16 v[184:187], v[112:115], v[40:43], v[184:187]
    ds_read_b128 v[64:67], v24 offset:49152
    ds_read_b128 v[68:71], v25 offset:49152
    v_mfma_f32_16x16x32_bf16 v[184:187], v[116:119], v[44:47], v[184:187]
    ds_read_b128 v[72:75], v24 offset:51200
    ds_read_b128 v[76:79], v25 offset:51200
    v_mfma_f32_16x16x32_bf16 v[192:195], v[112:115], v[48:51], v[192:195]
    ds_read_b128 v[80:83], v24 offset:53248
    ds_read_b128 v[84:87], v25 offset:53248
    v_mfma_f32_16x16x32_bf16 v[192:195], v[116:119], v[52:55], v[192:195]
    ds_read_b128 v[88:91], v24 offset:55296
    v_mfma_f32_16x16x32_bf16 v[200:203], v[112:115], v[56:59], v[200:203]
    ds_read_b128 v[92:95], v25 offset:55296
    v_mfma_f32_16x16x32_bf16 v[200:203], v[116:119], v[60:63], v[200:203]
    ds_read_b64_tr_b16 v[104:105], v27 offset:49152
    v_mfma_f32_16x16x32_bf16 v[180:183], v[120:123], v[32:35], v[180:183]
    ds_read_b64_tr_b16 v[106:107], v27 offset:50176
    v_mfma_f32_16x16x32_bf16 v[180:183], v[124:127], v[36:39], v[180:183]
    ds_read_b64_tr_b16 v[108:109], v27 offset:57344
    v_mfma_f32_16x16x32_bf16 v[188:191], v[120:123], v[40:43], v[188:191]
    ds_read_b64_tr_b16 v[110:111], v27 offset:58368
    v_mfma_f32_16x16x32_bf16 v[188:191], v[124:127], v[44:47], v[188:191]
    v_mfma_f32_16x16x32_bf16 v[196:199], v[120:123], v[48:51], v[196:199]
    v_mfma_f32_16x16x32_bf16 v[196:199], v[124:127], v[52:55], v[196:199]
    v_mfma_f32_16x16x32_bf16 v[204:207], v[120:123], v[56:59], v[204:207]
    v_mfma_f32_16x16x32_bf16 v[204:207], v[124:127], v[60:63], v[204:207]
    s_waitcnt lgkmcnt(0)
    s_nop 0
    v_mfma_f32_16x16x32_bf16 v[144:147], v[96:99], v[64:67], v[144:147]
    ds_read_b64_tr_b16 v[112:113], v28 offset:49152
    v_mfma_f32_16x16x32_bf16 v[144:147], v[100:103], v[68:71], v[144:147]
    ds_read_b64_tr_b16 v[114:115], v28 offset:50176
    v_mfma_f32_16x16x32_bf16 v[152:155], v[96:99], v[72:75], v[152:155]
    ds_read_b64_tr_b16 v[116:117], v28 offset:57344
    v_mfma_f32_16x16x32_bf16 v[152:155], v[100:103], v[76:79], v[152:155]
    ds_read_b64_tr_b16 v[118:119], v28 offset:58368
    v_mfma_f32_16x16x32_bf16 v[160:163], v[96:99], v[80:83], v[160:163]
    ds_read_b64_tr_b16 v[120:121], v29 offset:49152
    v_mfma_f32_16x16x32_bf16 v[160:163], v[100:103], v[84:87], v[160:163]
    ds_read_b64_tr_b16 v[122:123], v29 offset:50176
    v_mfma_f32_16x16x32_bf16 v[168:171], v[96:99], v[88:91], v[168:171]
    ds_read_b64_tr_b16 v[124:125], v29 offset:57344
    v_mfma_f32_16x16x32_bf16 v[168:171], v[100:103], v[92:95], v[168:171]
    ds_read_b64_tr_b16 v[126:127], v29 offset:58368
    v_mfma_f32_16x16x32_bf16 v[148:151], v[104:107], v[64:67], v[148:151]
    ds_read_b128 v[240:243], v128 offset:0
    v_mfma_f32_16x16x32_bf16 v[148:151], v[108:111], v[68:71], v[148:151]
    ds_read_b128 v[244:247], v128 offset:2048
    v_mfma_f32_16x16x32_bf16 v[156:159], v[104:107], v[72:75], v[156:159]
    ds_read_b128 v[248:251], v128 offset:4160
    v_mfma_f32_16x16x32_bf16 v[156:159], v[108:111], v[76:79], v[156:159]
    ds_read_b128 v[252:255], v128 offset:6208
    v_mfma_f32_16x16x32_bf16 v[164:167], v[104:107], v[80:83], v[164:167]
    v_mfma_f32_16x16x32_bf16 v[164:167], v[108:111], v[84:87], v[164:167]
    v_mfma_f32_16x16x32_bf16 v[172:175], v[104:107], v[88:91], v[172:175]
    v_mfma_f32_16x16x32_bf16 v[172:175], v[108:111], v[92:95], v[172:175]
    s_waitcnt lgkmcnt(0)
    s_barrier
    v_mfma_f32_16x16x32_bf16 v[176:179], v[112:115], v[64:67], v[176:179]
    ds_read_b64_tr_b16 v[96:97], v26 offset:0
    ds_read_b64_tr_b16 v[98:99], v26 offset:1024
    v_mfma_f32_16x16x32_bf16 v[176:179], v[116:119], v[68:71], v[176:179]
    ds_read_b64_tr_b16 v[100:101], v26 offset:8192
    ds_read_b64_tr_b16 v[102:103], v26 offset:9216
    v_mfma_f32_16x16x32_bf16 v[184:187], v[112:115], v[72:75], v[184:187]
    ds_read_b128 v[32:35], v24 offset:0
    ds_read_b128 v[36:39], v25 offset:0
    v_mfma_f32_16x16x32_bf16 v[184:187], v[116:119], v[76:79], v[184:187]
    ds_read_b128 v[40:43], v24 offset:2048
    ds_read_b128 v[44:47], v25 offset:2048
    v_mfma_f32_16x16x32_bf16 v[192:195], v[112:115], v[80:83], v[192:195]
    ds_read_b128 v[48:51], v24 offset:4096
    ds_read_b128 v[52:55], v25 offset:4096
    v_mfma_f32_16x16x32_bf16 v[192:195], v[116:119], v[84:87], v[192:195]
    ds_read_b128 v[56:59], v24 offset:6144
    v_mfma_f32_16x16x32_bf16 v[200:203], v[112:115], v[88:91], v[200:203]
    ds_read_b128 v[60:63], v25 offset:6144
    v_mfma_f32_16x16x32_bf16 v[200:203], v[116:119], v[92:95], v[200:203]
    ds_read_b64_tr_b16 v[104:105], v27 offset:0
PADG1:
    s_cbranch_execz WR44
    v_mfma_f32_16x16x32_bf16 v[180:183], v[120:123], v[64:67], v[180:183]
    ds_read_b64_tr_b16 v[106:107], v27 offset:1024
    v_mfma_f32_16x16x32_bf16 v[180:183], v[124:127], v[68:71], v[180:183]
    ds_read_b64_tr_b16 v[108:109], v27 offset:8192
    v_mfma_f32_16x16x32_bf16 v[188:191], v[120:123], v[72:75], v[188:191]
    ds_read_b64_tr_b16 v[110:111], v27 offset:9216
    v_mfma_f32_16x16x32_bf16 v[188:191], v[124:127], v[76:79], v[188:191]
    v_mfma_f32_16x16x32_bf16 v[196:199], v[120:123], v[80:83], v[196:199]
    v_mfma_f32_16x16x32_bf16 v[196:199], v[124:127], v[84:87], v[196:199]
    v_mfma_f32_16x16x32_bf16 v[204:207], v[120:123], v[88:91], v[204:207]
    v_mfma_f32_16x16x32_bf16 v[204:207], v[124:127], v[92:95], v[204:207]
    s_waitcnt lgkmcnt(0)
    v_mfma_f32_16x16x32_bf16 v[144:147], v[96:99], v[32:35], v[144:147]
    ds_read_b64_tr_b16 v[112:113], v28 offset:0
    v_mfma_f32_16x16x32_bf16 v[144:147], v[100:103], v[36:39], v[144:147]
    ds_read_b64_tr_b16 v[114:115], v28 offset:1024
    v_mfma_f32_16x16x32_bf16 v[152:155], v[96:99], v[40:43], v[152:155]
    ds_read_b64_tr_b16 v[116:117], v28 offset:8192
    v_mfma_f32_16x16x32_bf16 v[152:155], v[100:103], v[44:47], v[152:155]
    ds_read_b64_tr_b16 v[118:119], v28 offset:9216
    v_mfma_f32_16x16x32_bf16 v[160:163], v[96:99], v[48:51], v[160:163]
    ds_read_b64_tr_b16 v[120:121], v29 offset:0
    v_mfma_f32_16x16x32_bf16 v[160:163], v[100:103], v[52:55], v[160:163]
    ds_read_b64_tr_b16 v[122:123], v29 offset:1024
    v_mfma_f32_16x16x32_bf16 v[168:171], v[96:99], v[56:59], v[168:171]
    ds_read_b64_tr_b16 v[124:125], v29 offset:8192
    v_mfma_f32_16x16x32_bf16 v[168:171], v[100:103], v[60:63], v[168:171]
    ds_read_b64_tr_b16 v[126:127], v29 offset:9216
    v_mfma_f32_16x16x32_bf16 v[148:151], v[104:107], v[32:35], v[148:151]
    v_mfma_f32_16x16x32_bf16 v[148:151], v[108:111], v[36:39], v[148:151]
    v_mfma_f32_16x16x32_bf16 v[156:159], v[104:107], v[40:43], v[156:159]
    v_mfma_f32_16x16x32_bf16 v[156:159], v[108:111], v[44:47], v[156:159]
    v_mfma_f32_16x16x32_bf16 v[164:167], v[104:107], v[48:51], v[164:167]
    v_mfma_f32_16x16x32_bf16 v[164:167], v[108:111], v[52:55], v[164:167]
    v_mfma_f32_16x16x32_bf16 v[172:175], v[104:107], v[56:59], v[172:175]
    v_mfma_f32_16x16x32_bf16 v[172:175], v[108:111], v[60:63], v[172:175]
    s_waitcnt lgkmcnt(0)
    s_barrier
    v_mfma_f32_16x16x32_bf16 v[176:179], v[112:115], v[32:35], v[176:179]
    ds_read_b64_tr_b16 v[96:97], v26 offset:16384
    ds_read_b64_tr_b16 v[98:99], v26 offset:17408
    v_mfma_f32_16x16x32_bf16 v[176:179], v[116:119], v[36:39], v[176:179]
    ds_read_b64_tr_b16 v[100:101], v26 offset:24576
    ds_read_b64_tr_b16 v[102:103], v26 offset:25600
    v_mfma_f32_16x16x32_bf16 v[184:187], v[112:115], v[40:43], v[184:187]
    ds_read_b128 v[64:67], v24 offset:16384
    ds_read_b128 v[68:71], v25 offset:16384
    v_mfma_f32_16x16x32_bf16 v[184:187], v[116:119], v[44:47], v[184:187]
    ds_read_b128 v[72:75], v24 offset:18432
    ds_read_b128 v[76:79], v25 offset:18432
    v_mfma_f32_16x16x32_bf16 v[192:195], v[112:115], v[48:51], v[192:195]
    ds_read_b128 v[80:83], v24 offset:20480
    ds_read_b128 v[84:87], v25 offset:20480
    v_mfma_f32_16x16x32_bf16 v[192:195], v[116:119], v[52:55], v[192:195]
    ds_read_b128 v[88:91], v24 offset:22528
    v_mfma_f32_16x16x32_bf16 v[200:203], v[112:115], v[56:59], v[200:203]
    ds_read_b128 v[92:95], v25 offset:22528
    v_mfma_f32_16x16x32_bf16 v[200:203], v[116:119], v[60:63], v[200:203]
    ds_read_b64_tr_b16 v[104:105], v27 offset:16384
    v_mfma_f32_16x16x32_bf16 v[180:183], v[120:123], v[32:35], v[180:183]
    ds_read_b64_tr_b16 v[106:107], v27 offset:17408
    v_mfma_f32_16x16x32_bf16 v[180:183], v[124:127], v[36:39], v[180:183]
    ds_read_b64_tr_b16 v[108:109], v27 offset:24576
    v_mfma_f32_16x16x32_bf16 v[188:191], v[120:123], v[40:43], v[188:191]
    ds_read_b64_tr_b16 v[110:111], v27 offset:25600
    v_mfma_f32_16x16x32_bf16 v[188:191], v[124:127], v[44:47], v[188:191]
    v_mfma_f32_16x16x32_bf16 v[196:199], v[120:123], v[48:51], v[196:199]
    v_mfma_f32_16x16x32_bf16 v[196:199], v[124:127], v[52:55], v[196:199]
    v_mfma_f32_16x16x32_bf16 v[204:207], v[120:123], v[56:59], v[204:207]
    v_mfma_f32_16x16x32_bf16 v[204:207], v[124:127], v[60:63], v[204:207]
    s_waitcnt lgkmcnt(0)
    s_nop 0
    v_mfma_f32_16x16x32_bf16 v[144:147], v[96:99], v[64:67], v[144:147]
    ds_read_b64_tr_b16 v[112:113], v28 offset:16384
    ds_read_b64_tr_b16 v[114:115], v28 offset:17408
    v_mfma_f32_16x16x32_bf16 v[144:147], v[100:103], v[68:71], v[144:147]
    ds_read_b64_tr_b16 v[116:117], v28 offset:24576
    ds_read_b64_tr_b16 v[118:119], v28 offset:25600
    v_mfma_f32_16x16x32_bf16 v[152:155], v[96:99], v[72:75], v[152:155]
    ds_read_b64_tr_b16 v[120:121], v29 offset:16384
    ds_read_b64_tr_b16 v[122:123], v29 offset:17408
    v_mfma_f32_16x16x32_bf16 v[152:155], v[100:103], v[76:79], v[152:155]
    ds_read_b64_tr_b16 v[124:125], v29 offset:24576
    ds_read_b64_tr_b16 v[126:127], v29 offset:25600
    v_mfma_f32_16x16x32_bf16 v[160:163], v[96:99], v[80:83], v[160:163]
    ds_read_b128 v[32:35], v129 offset:0
    ds_read_b128 v[36:39], v129 offset:128
    v_mfma_f32_16x16x32_bf16 v[160:163], v[100:103], v[84:87], v[160:163]
    ds_read_b128 v[40:43], v129 offset:512
    ds_read_b128 v[44:47], v129 offset:640
    v_mfma_f32_16x16x32_bf16 v[168:171], v[96:99], v[88:91], v[168:171]
    ds_read_b128 v[48:51], v130 offset:0
    ds_read_b128 v[52:55], v130 offset:512
    v_mfma_f32_16x16x32_bf16 v[168:171], v[100:103], v[92:95], v[168:171]
    ds_read_b128 v[56:59], v130 offset:1024
    ds_read_b128 v[60:63], v130 offset:1536
    v_mfma_f32_16x16x32_bf16 v[148:151], v[104:107], v[64:67], v[148:151]
    ds_read_b64 v[228:229], v130 offset:16
    ds_read_b64 v[230:231], v130 offset:528
    v_mfma_f32_16x16x32_bf16 v[148:151], v[108:111], v[68:71], v[148:151]
    ds_read_b64 v[232:233], v130 offset:1040
    ds_read_b64 v[234:235], v130 offset:1552
    v_mfma_f32_16x16x32_bf16 v[156:159], v[104:107], v[72:75], v[156:159]
    ds_read_b32 v236, v130 offset:24
    ds_read_b32 v237, v130 offset:536
    v_mfma_f32_16x16x32_bf16 v[156:159], v[108:111], v[76:79], v[156:159]
    ds_read_b32 v238, v130 offset:1048
    ds_read_b32 v239, v130 offset:1560
    v_mfma_f32_16x16x32_bf16 v[164:167], v[104:107], v[80:83], v[164:167]
    v_mfma_f32_16x16x32_bf16 v[164:167], v[108:111], v[84:87], v[164:167]
    v_mfma_f32_16x16x32_bf16 v[172:175], v[104:107], v[88:91], v[172:175]
    v_mfma_f32_16x16x32_bf16 v[172:175], v[108:111], v[92:95], v[172:175]
    s_waitcnt lgkmcnt(0)
    s_barrier
    v_mfma_f32_16x16x32_bf16 v[176:179], v[112:115], v[64:67], v[176:179]
    ds_read_b64_tr_b16 v[96:97], v4 offset:32768
    v_mfma_f32_16x16x32_bf16 v[176:179], v[116:119], v[68:71], v[176:179]
    ds_read_b64_tr_b16 v[98:99], v4 offset:33792
    v_mfma_f32_16x16x32_bf16 v[184:187], v[112:115], v[72:75], v[184:187]
    ds_read_b64_tr_b16 v[100:101], v5 offset:32768
    v_mfma_f32_16x16x32_bf16 v[184:187], v[116:119], v[76:79], v[184:187]
    ds_read_b64_tr_b16 v[102:103], v5 offset:33792
    v_mfma_f32_16x16x32_bf16 v[192:195], v[112:115], v[80:83], v[192:195]
    ds_read_b64_tr_b16 v[104:105], v6 offset:32768
    v_mfma_f32_16x16x32_bf16 v[192:195], v[116:119], v[84:87], v[192:195]
    ds_read_b64_tr_b16 v[106:107], v6 offset:33792
    v_mfma_f32_16x16x32_bf16 v[200:203], v[112:115], v[88:91], v[200:203]
    ds_read_b64_tr_b16 v[108:109], v7 offset:32768
    v_mfma_f32_16x16x32_bf16 v[200:203], v[116:119], v[92:95], v[200:203]
    ds_read_b64_tr_b16 v[110:111], v7 offset:33792
    v_mfma_f32_16x16x32_bf16 v[180:183], v[120:123], v[64:67], v[180:183]
    ds_read_b64_tr_b16 v[128:129], v4 offset:40960
    v_mfma_f32_16x16x32_bf16 v[180:183], v[124:127], v[68:71], v[180:183]
    ds_read_b64_tr_b16 v[130:131], v4 offset:41984
    v_mfma_f32_16x16x32_bf16 v[188:191], v[120:123], v[72:75], v[188:191]
    ds_read_b64_tr_b16 v[132:133], v5 offset:40960
    v_mfma_f32_16x16x32_bf16 v[188:191], v[124:127], v[76:79], v[188:191]
    ds_read_b64_tr_b16 v[134:135], v5 offset:41984
    v_mfma_f32_16x16x32_bf16 v[196:199], v[120:123], v[80:83], v[196:199]
    ds_read_b64_tr_b16 v[136:137], v6 offset:40960
    v_mfma_f32_16x16x32_bf16 v[196:199], v[124:127], v[84:87], v[196:199]
    ds_read_b64_tr_b16 v[138:139], v6 offset:41984
    v_mfma_f32_16x16x32_bf16 v[204:207], v[120:123], v[88:91], v[204:207]
    ds_read_b64_tr_b16 v[140:141], v7 offset:40960
    v_mfma_f32_16x16x32_bf16 v[204:207], v[124:127], v[92:95], v[204:207]
    ds_read_b64_tr_b16 v[142:143], v7 offset:41984
    v_mfma_f32_16x16x32_bf16 v[144:147], v[32:35], v[48:51], v[144:147]
    ds_read_b64_tr_b16 v[64:65], v16 offset:32768
    v_mfma_f32_16x16x32_bf16 v[148:151], v[36:39], v[48:51], v[148:151]
    ds_read_b64_tr_b16 v[66:67], v16 offset:33792
    v_mfma_f32_16x16x32_bf16 v[152:155], v[32:35], v[52:55], v[152:155]
    ds_read_b64_tr_b16 v[68:69], v17 offset:32768
    v_mfma_f32_16x16x32_bf16 v[156:159], v[36:39], v[52:55], v[156:159]
    ds_read_b64_tr_b16 v[70:71], v17 offset:33792
    v_mfma_f32_16x16x32_bf16 v[160:163], v[32:35], v[56:59], v[160:163]
    ds_read_b64_tr_b16 v[72:73], v18 offset:32768
    v_mfma_f32_16x16x32_bf16 v[164:167], v[36:39], v[56:59], v[164:167]
    ds_read_b64_tr_b16 v[74:75], v18 offset:33792
    v_mfma_f32_16x16x32_bf16 v[168:171], v[32:35], v[60:63], v[168:171]
    ds_read_b64_tr_b16 v[76:77], v19 offset:32768
    v_mfma_f32_16x16x32_bf16 v[172:175], v[36:39], v[60:63], v[172:175]
    ds_read_b64_tr_b16 v[78:79], v19 offset:33792
    v_mfma_f32_16x16x32_bf16 v[176:179], v[40:43], v[48:51], v[176:179]
    ds_read_b64_tr_b16 v[80:81], v16 offset:40960
    v_mfma_f32_16x16x32_bf16 v[180:183], v[44:47], v[48:51], v[180:183]
    ds_read_b64_tr_b16 v[82:83], v16 offset:41984
    v_mfma_f32_16x16x32_bf16 v[184:187], v[40:43], v[52:55], v[184:187]
    ds_read_b64_tr_b16 v[84:85], v17 offset:40960
    v_mfma_f32_16x16x32_bf16 v[188:191], v[44:47], v[52:55], v[188:191]
    ds_read_b64_tr_b16 v[86:87], v17 offset:41984
    v_mfma_f32_16x16x32_bf16 v[192:195], v[40:43], v[56:59], v[192:195]
    ds_read_b64_tr_b16 v[88:89], v18 offset:40960
    v_mfma_f32_16x16x32_bf16 v[196:199], v[44:47], v[56:59], v[196:199]
    ds_read_b64_tr_b16 v[90:91], v18 offset:41984
    v_mfma_f32_16x16x32_bf16 v[200:203], v[40:43], v[60:63], v[200:203]
    ds_read_b64_tr_b16 v[92:93], v19 offset:40960
    v_mfma_f32_16x16x32_bf16 v[204:207], v[44:47], v[60:63], v[204:207]
    ds_read_b64_tr_b16 v[94:95], v19 offset:41984
    s_barrier
    s_nop 0
    v_pk_mul_f32 v[208:209], v[144:145], v[144:145]
    v_pk_fma_f32 v[208:209], v[208:209], v[228:229], v[228:229] op_sel:[0,0,1] op_sel_hi:[1,0,1]
    v_pk_mul_f32 v[208:209], v[208:209], v[144:145]
    v_pk_mul_f32 v[210:211], v[146:147], v[146:147]
    v_pk_fma_f32 v[210:211], v[210:211], v[228:229], v[228:229] op_sel:[0,0,1] op_sel_hi:[1,0,1]
    v_pk_mul_f32 v[210:211], v[210:211], v[146:147]
    v_pk_mul_f32 v[212:213], v[148:149], v[148:149]
    v_exp_f32 v208, v208
    v_pk_fma_f32 v[212:213], v[212:213], v[228:229], v[228:229] op_sel:[0,0,1] op_sel_hi:[1,0,1]
    v_exp_f32 v209, v209
    v_pk_mul_f32 v[212:213], v[212:213], v[148:149]
    v_pk_mul_f32 v[214:215], v[150:151], v[150:151]
    v_exp_f32 v210, v210
    v_pk_fma_f32 v[214:215], v[214:215], v[228:229], v[228:229] op_sel:[0,0,1] op_sel_hi:[1,0,1]
    v_exp_f32 v211, v211
    v_pk_mul_f32 v[214:215], v[214:215], v[150:151]
    v_pk_fma_f32 v[208:209], v[208:209], v[236:237], v[236:237] op_sel:[0,0,0] op_sel_hi:[1,0,0]
    v_pk_mul_f32 v[216:217], v[152:153], v[152:153]
    v_exp_f32 v212, v212
    v_pk_fma_f32 v[216:217], v[216:217], v[230:231], v[230:231] op_sel:[0,0,1] op_sel_hi:[1,0,1]
    v_exp_f32 v213, v213
    v_pk_mul_f32 v[216:217], v[216:217], v[152:153]
    v_pk_fma_f32 v[210:211], v[210:211], v[236:237], v[236:237] op_sel:[0,0,0] op_sel_hi:[1,0,0]
    v_rcp_f32 v208, v208
    v_rcp_f32 v209, v209
    v_pk_mul_f32 v[218:219], v[154:155], v[154:155]
    v_exp_f32 v214, v214
    v_pk_fma_f32 v[218:219], v[218:219], v[230:231], v[230:231] op_sel:[0,0,1] op_sel_hi:[1,0,1]
    v_exp_f32 v215, v215
    v_pk_mul_f32 v[218:219], v[218:219], v[154:155]
    v_pk_fma_f32 v[212:213], v[212:213], v[236:237], v[236:237] op_sel:[0,0,0] op_sel_hi:[1,0,0]
    v_rcp_f32 v210, v210
    v_pk_mul_f32 v[208:209], v[208:209], v[144:145]
    v_rcp_f32 v211, v211
    v_pk_mul_f32 v[220:221], v[156:157], v[156:157]
    v_exp_f32 v216, v216
    v_pk_fma_f32 v[220:221], v[220:221], v[230:231], v[230:231] op_sel:[0,0,1] op_sel_hi:[1,0,1]
    v_exp_f32 v217, v217
    v_pk_mul_f32 v[220:221], v[220:221], v[156:157]
    v_pk_fma_f32 v[214:215], v[214:215], v[236:237], v[236:237] op_sel:[0,0,0] op_sel_hi:[1,0,0]
    v_rcp_f32 v212, v212
    v_pk_mul_f32 v[210:211], v[210:211], v[146:147]
    v_rcp_f32 v213, v213
    v_cvt_pk_bf16_f32 v224, v208, v209
    v_pk_mul_f32 v[222:223], v[158:159], v[158:159]
    v_exp_f32 v218, v218
    v_pk_fma_f32 v[222:223], v[222:223], v[230:231], v[230:231] op_sel:[0,0,1] op_sel_hi:[1,0,1]
    v_exp_f32 v219, v219
    v_pk_mul_f32 v[222:223], v[222:223], v[158:159]
    v_pk_fma_f32 v[216:217], v[216:217], v[236:237], v[236:237] op_sel:[0,1,1] op_sel_hi:[1,1,1]
    v_rcp_f32 v214, v214
    v_pk_mul_f32 v[212:213], v[212:213], v[148:149]
    v_rcp_f32 v215, v215
    v_cvt_pk_bf16_f32 v225, v210, v211
    v_pk_mul_f32 v[208:209], v[160:161], v[160:161]
    v_exp_f32 v220, v220
    v_pk_fma_f32 v[208:209], v[208:209], v[232:233], v[232:233] op_sel:[0,0,1] op_sel_hi:[1,0,1]
    v_exp_f32 v221, v221
    v_pk_mul_f32 v[208:209], v[208:209], v[160:161]
    v_pk_fma_f32 v[218:219], v[218:219], v[236:237], v[236:237] op_sel:[0,1,1] op_sel_hi:[1,1,1]
    v_rcp_f32 v216, v216
    v_pk_mul_f32 v[214:215], v[214:215], v[150:151]
    v_rcp_f32 v217, v217
    v_cvt_pk_bf16_f32 v226, v212, v213
    s_add_u32 s69, s68, 0
    v_pk_mul_f32 v[210:211], v[162:163], v[162:163]
    v_exp_f32 v222, v222
    v_pk_fma_f32 v[210:211], v[210:211], v[232:233], v[232:233] op_sel:[0,0,1] op_sel_hi:[1,0,1]
    v_exp_f32_e64 v223, v223
    v_pk_mul_f32 v[210:211], v[210:211], v[162:163]
    v_pk_fma_f32 v[220:221], v[220:221], v[236:237], v[236:237] op_sel:[0,1,1] op_sel_hi:[1,1,1]
    v_rcp_f32 v218, v218
    v_pk_mul_f32 v[216:217], v[216:217], v[152:153]
    v_rcp_f32 v219, v219
    v_cvt_pk_bf16_f32 v227, v214, v215
    buffer_store_dwordx4 v[224:227], v2, s[52:55], s69 offen sc1
    v_pk_mul_f32 v[212:213], v[164:165], v[164:165]
    v_exp_f32 v208, v208
    v_pk_fma_f32 v[212:213], v[212:213], v[232:233], v[232:233] op_sel:[0,0,1] op_sel_hi:[1,0,1]
    v_exp_f32 v209, v209
    v_pk_mul_f32 v[212:213], v[212:213], v[164:165]
    v_pk_fma_f32 v[222:223], v[222:223], v[236:237], v[236:237] op_sel:[0,1,1] op_sel_hi:[1,1,1]
    v_rcp_f32 v220, v220
    v_pk_mul_f32 v[218:219], v[218:219], v[154:155]
    v_rcp_f32 v221, v221
    v_cvt_pk_bf16_f32 v224, v216, v217
    v_pk_mul_f32 v[214:215], v[166:167], v[166:167]
    v_exp_f32 v210, v210
    v_pk_fma_f32 v[214:215], v[214:215], v[232:233], v[232:233] op_sel:[0,0,1] op_sel_hi:[1,0,1]
    v_exp_f32 v211, v211
    v_pk_mul_f32 v[214:215], v[214:215], v[166:167]
    v_pk_fma_f32 v[208:209], v[208:209], v[238:239], v[238:239] op_sel:[0,0,0] op_sel_hi:[1,0,0]
    v_rcp_f32 v222, v222
    v_pk_mul_f32 v[220:221], v[220:221], v[156:157]
    v_rcp_f32 v223, v223
    v_cvt_pk_bf16_f32 v225, v218, v219
    v_pk_mul_f32 v[216:217], v[168:169], v[168:169]
    v_exp_f32 v212, v212
    v_pk_fma_f32 v[216:217], v[216:217], v[234:235], v[234:235] op_sel:[0,0,1] op_sel_hi:[1,0,1]
    v_exp_f32 v213, v213
    v_pk_mul_f32 v[216:217], v[216:217], v[168:169]
    v_pk_fma_f32 v[210:211], v[210:211], v[238:239], v[238:239] op_sel:[0,0,0] op_sel_hi:[1,0,0]
    v_rcp_f32 v208, v208
    v_pk_mul_f32 v[222:223], v[222:223], v[158:159]
    v_rcp_f32 v209, v209
    v_cvt_pk_bf16_f32 v226, v220, v221
    s_add_u32 s69, s68, 49152
    v_pk_mul_f32 v[218:219], v[170:171], v[170:171]
    v_exp_f32 v214, v214
    v_pk_fma_f32 v[218:219], v[218:219], v[234:235], v[234:235] op_sel:[0,0,1] op_sel_hi:[1,0,1]
    v_exp_f32 v215, v215
    v_pk_mul_f32 v[218:219], v[218:219], v[170:171]
    v_pk_fma_f32 v[212:213], v[212:213], v[238:239], v[238:239] op_sel:[0,0,0] op_sel_hi:[1,0,0]
    v_rcp_f32 v210, v210
    v_pk_mul_f32 v[208:209], v[208:209], v[160:161]
    v_rcp_f32 v211, v211
    v_cvt_pk_bf16_f32 v227, v222, v223
    buffer_store_dwordx4 v[224:227], v2, s[52:55], s69 offen sc1
    v_pk_mul_f32 v[220:221], v[172:173], v[172:173]
    v_exp_f32 v216, v216
    v_pk_fma_f32 v[220:221], v[220:221], v[234:235], v[234:235] op_sel:[0,0,1] op_sel_hi:[1,0,1]
    v_exp_f32 v217, v217
    v_pk_mul_f32 v[220:221], v[220:221], v[172:173]
    v_pk_fma_f32 v[214:215], v[214:215], v[238:239], v[238:239] op_sel:[0,0,0] op_sel_hi:[1,0,0]
    v_rcp_f32 v212, v212
    v_pk_mul_f32 v[210:211], v[210:211], v[162:163]
    v_rcp_f32 v213, v213
    v_cvt_pk_bf16_f32 v224, v208, v209
    v_pk_mul_f32 v[222:223], v[174:175], v[174:175]
    v_exp_f32 v218, v218
    v_pk_fma_f32 v[222:223], v[222:223], v[234:235], v[234:235] op_sel:[0,0,1] op_sel_hi:[1,0,1]
    v_exp_f32 v219, v219
    v_pk_mul_f32 v[222:223], v[222:223], v[174:175]
    v_pk_fma_f32 v[216:217], v[216:217], v[238:239], v[238:239] op_sel:[0,1,1] op_sel_hi:[1,1,1]
    v_rcp_f32 v214, v214
    v_pk_mul_f32 v[212:213], v[212:213], v[164:165]
    v_rcp_f32 v215, v215
    v_cvt_pk_bf16_f32 v225, v210, v211
    v_pk_mul_f32 v[208:209], v[176:177], v[176:177]
    v_exp_f32 v220, v220
    v_pk_fma_f32 v[208:209], v[208:209], v[228:229], v[228:229] op_sel:[0,0,1] op_sel_hi:[1,0,1]
    v_exp_f32 v221, v221
    v_pk_mul_f32 v[208:209], v[208:209], v[176:177]
    v_pk_fma_f32 v[218:219], v[218:219], v[238:239], v[238:239] op_sel:[0,1,1] op_sel_hi:[1,1,1]
    v_rcp_f32 v216, v216
    v_pk_mul_f32 v[214:215], v[214:215], v[166:167]
    v_rcp_f32 v217, v217
    v_cvt_pk_bf16_f32 v226, v212, v213
    s_add_u32 s69, s68, 98304
    v_pk_mul_f32 v[210:211], v[178:179], v[178:179]
    v_exp_f32 v222, v222
    v_pk_fma_f32 v[210:211], v[210:211], v[228:229], v[228:229] op_sel:[0,0,1] op_sel_hi:[1,0,1]
    v_exp_f32 v223, v223
    v_pk_mul_f32 v[210:211], v[210:211], v[178:179]
    v_pk_fma_f32 v[220:221], v[220:221], v[238:239], v[238:239] op_sel:[0,1,1] op_sel_hi:[1,1,1]
    v_rcp_f32 v218, v218
    v_pk_mul_f32 v[216:217], v[216:217], v[168:169]
    v_rcp_f32 v219, v219
    v_cvt_pk_bf16_f32 v227, v214, v215
    buffer_store_dwordx4 v[224:227], v2, s[52:55], s69 offen sc1
    v_pk_mul_f32 v[212:213], v[180:181], v[180:181]
    v_exp_f32 v208, v208
    v_pk_fma_f32 v[212:213], v[212:213], v[228:229], v[228:229] op_sel:[0,0,1] op_sel_hi:[1,0,1]
    v_exp_f32 v209, v209
    v_pk_mul_f32 v[212:213], v[212:213], v[180:181]
    v_pk_fma_f32 v[222:223], v[222:223], v[238:239], v[238:239] op_sel:[0,1,1] op_sel_hi:[1,1,1]
    v_rcp_f32 v220, v220
    v_pk_mul_f32 v[218:219], v[218:219], v[170:171]
    v_rcp_f32 v221, v221
    v_cvt_pk_bf16_f32 v224, v216, v217
    v_pk_mul_f32 v[214:215], v[182:183], v[182:183]
    v_exp_f32 v210, v210
    v_pk_fma_f32 v[214:215], v[214:215], v[228:229], v[228:229] op_sel:[0,0,1] op_sel_hi:[1,0,1]
    v_exp_f32 v211, v211
    v_pk_mul_f32 v[214:215], v[214:215], v[182:183]
    v_pk_fma_f32 v[208:209], v[208:209], v[236:237], v[236:237] op_sel:[0,0,0] op_sel_hi:[1,0,0]
    v_rcp_f32 v222, v222
    v_pk_mul_f32 v[220:221], v[220:221], v[172:173]
    v_rcp_f32 v223, v223
    v_cvt_pk_bf16_f32 v225, v218, v219
    v_pk_mul_f32 v[216:217], v[184:185], v[184:185]
    v_exp_f32 v212, v212
    v_pk_fma_f32 v[216:217], v[216:217], v[230:231], v[230:231] op_sel:[0,0,1] op_sel_hi:[1,0,1]
    v_exp_f32 v213, v213
    v_pk_mul_f32 v[216:217], v[216:217], v[184:185]
    v_pk_fma_f32 v[210:211], v[210:211], v[236:237], v[236:237] op_sel:[0,0,0] op_sel_hi:[1,0,0]
    v_rcp_f32 v208, v208
    v_pk_mul_f32 v[222:223], v[222:223], v[174:175]
    v_rcp_f32 v209, v209
    v_cvt_pk_bf16_f32 v226, v220, v221
    s_add_u32 s69, s68, 147456
    v_pk_mul_f32 v[218:219], v[186:187], v[186:187]
    v_exp_f32 v214, v214
    v_pk_fma_f32 v[218:219], v[218:219], v[230:231], v[230:231] op_sel:[0,0,1] op_sel_hi:[1,0,1]
    v_exp_f32 v215, v215
    v_pk_mul_f32 v[218:219], v[218:219], v[186:187]
    v_pk_fma_f32 v[212:213], v[212:213], v[236:237], v[236:237] op_sel:[0,0,0] op_sel_hi:[1,0,0]
    v_rcp_f32 v210, v210
    v_pk_mul_f32 v[208:209], v[208:209], v[176:177]
    v_rcp_f32 v211, v211
    v_cvt_pk_bf16_f32 v227, v222, v223
    buffer_store_dwordx4 v[224:227], v2, s[52:55], s69 offen sc1
    v_pk_mul_f32 v[220:221], v[188:189], v[188:189]
    v_exp_f32 v216, v216
    v_pk_fma_f32 v[220:221], v[220:221], v[230:231], v[230:231] op_sel:[0,0,1] op_sel_hi:[1,0,1]
    v_exp_f32 v217, v217
    v_pk_mul_f32 v[220:221], v[220:221], v[188:189]
    v_pk_fma_f32 v[214:215], v[214:215], v[236:237], v[236:237] op_sel:[0,0,0] op_sel_hi:[1,0,0]
    v_rcp_f32 v212, v212
    v_pk_mul_f32 v[210:211], v[210:211], v[178:179]
    v_rcp_f32 v213, v213
    v_cvt_pk_bf16_f32 v224, v208, v209
    v_pk_mul_f32 v[222:223], v[190:191], v[190:191]
    v_exp_f32 v218, v218
    v_pk_fma_f32 v[222:223], v[222:223], v[230:231], v[230:231] op_sel:[0,0,1] op_sel_hi:[1,0,1]
    v_exp_f32 v219, v219
    v_pk_mul_f32 v[222:223], v[222:223], v[190:191]
    v_pk_fma_f32 v[216:217], v[216:217], v[236:237], v[236:237] op_sel:[0,1,1] op_sel_hi:[1,1,1]
    v_rcp_f32 v214, v214
    v_pk_mul_f32 v[212:213], v[212:213], v[180:181]
    v_rcp_f32 v215, v215
    v_cvt_pk_bf16_f32 v225, v210, v211
    v_pk_mul_f32 v[208:209], v[192:193], v[192:193]
    v_exp_f32 v220, v220
    v_pk_fma_f32 v[208:209], v[208:209], v[232:233], v[232:233] op_sel:[0,0,1] op_sel_hi:[1,0,1]
    v_exp_f32 v221, v221
    v_pk_mul_f32 v[208:209], v[208:209], v[192:193]
    v_pk_fma_f32 v[218:219], v[218:219], v[236:237], v[236:237] op_sel:[0,1,1] op_sel_hi:[1,1,1]
    v_rcp_f32 v216, v216
    v_pk_mul_f32 v[214:215], v[214:215], v[182:183]
    v_rcp_f32 v217, v217
    v_cvt_pk_bf16_f32 v226, v212, v213
    s_add_u32 s69, s68, 24576
    v_pk_mul_f32 v[210:211], v[194:195], v[194:195]
    v_exp_f32 v222, v222
    v_pk_fma_f32 v[210:211], v[210:211], v[232:233], v[232:233] op_sel:[0,0,1] op_sel_hi:[1,0,1]
    v_exp_f32 v223, v223
    v_pk_mul_f32 v[210:211], v[210:211], v[194:195]
    v_pk_fma_f32 v[220:221], v[220:221], v[236:237], v[236:237] op_sel:[0,1,1] op_sel_hi:[1,1,1]
    v_rcp_f32 v218, v218
    v_pk_mul_f32 v[216:217], v[216:217], v[184:185]
    v_rcp_f32 v219, v219
    v_cvt_pk_bf16_f32 v227, v214, v215
    buffer_store_dwordx4 v[224:227], v2, s[52:55], s69 offen sc1
    v_pk_mul_f32 v[212:213], v[196:197], v[196:197]
    v_exp_f32 v208, v208
    v_pk_fma_f32 v[212:213], v[212:213], v[232:233], v[232:233] op_sel:[0,0,1] op_sel_hi:[1,0,1]
    v_exp_f32 v209, v209
    v_pk_mul_f32 v[212:213], v[212:213], v[196:197]
    v_pk_fma_f32 v[222:223], v[222:223], v[236:237], v[236:237] op_sel:[0,1,1] op_sel_hi:[1,1,1]
    v_rcp_f32 v220, v220
    v_pk_mul_f32 v[218:219], v[218:219], v[186:187]
    v_rcp_f32 v221, v221
    v_cvt_pk_bf16_f32 v224, v216, v217
    v_pk_mul_f32 v[214:215], v[198:199], v[198:199]
    v_exp_f32 v210, v210
    v_pk_fma_f32 v[214:215], v[214:215], v[232:233], v[232:233] op_sel:[0,0,1] op_sel_hi:[1,0,1]
    v_exp_f32 v211, v211
    v_pk_mul_f32 v[214:215], v[214:215], v[198:199]
    v_pk_fma_f32 v[208:209], v[208:209], v[238:239], v[238:239] op_sel:[0,0,0] op_sel_hi:[1,0,0]
    v_rcp_f32 v222, v222
    v_pk_mul_f32 v[220:221], v[220:221], v[188:189]
    v_rcp_f32 v223, v223
    v_cvt_pk_bf16_f32 v225, v218, v219
    v_pk_mul_f32 v[216:217], v[200:201], v[200:201]
    v_exp_f32 v212, v212
    v_pk_fma_f32 v[216:217], v[216:217], v[234:235], v[234:235] op_sel:[0,0,1] op_sel_hi:[1,0,1]
    v_exp_f32 v213, v213
    v_pk_mul_f32 v[216:217], v[216:217], v[200:201]
    v_pk_fma_f32 v[210:211], v[210:211], v[238:239], v[238:239] op_sel:[0,0,0] op_sel_hi:[1,0,0]
    v_rcp_f32 v208, v208
    v_pk_mul_f32 v[222:223], v[222:223], v[190:191]
    v_rcp_f32 v209, v209
    v_cvt_pk_bf16_f32 v226, v220, v221
    s_add_u32 s69, s68, 73728
    v_pk_mul_f32 v[218:219], v[202:203], v[202:203]
    v_exp_f32 v214, v214
    v_pk_fma_f32 v[218:219], v[218:219], v[234:235], v[234:235] op_sel:[0,0,1] op_sel_hi:[1,0,1]
    v_exp_f32 v215, v215
    v_pk_mul_f32 v[218:219], v[218:219], v[202:203]
    v_pk_fma_f32 v[212:213], v[212:213], v[238:239], v[238:239] op_sel:[0,0,0] op_sel_hi:[1,0,0]
    v_rcp_f32 v210, v210
    v_pk_mul_f32 v[208:209], v[208:209], v[192:193]
    v_rcp_f32 v211, v211
    v_cvt_pk_bf16_f32 v227, v222, v223
    buffer_store_dwordx4 v[224:227], v2, s[52:55], s69 offen sc1
    v_pk_mul_f32 v[220:221], v[204:205], v[204:205]
    v_exp_f32 v216, v216
    v_pk_fma_f32 v[220:221], v[220:221], v[234:235], v[234:235] op_sel:[0,0,1] op_sel_hi:[1,0,1]
    v_exp_f32 v217, v217
    v_pk_mul_f32 v[220:221], v[220:221], v[204:205]
    v_pk_fma_f32 v[214:215], v[214:215], v[238:239], v[238:239] op_sel:[0,0,0] op_sel_hi:[1,0,0]
    v_rcp_f32 v212, v212
    v_pk_mul_f32 v[210:211], v[210:211], v[194:195]
    v_rcp_f32 v213, v213
    v_cvt_pk_bf16_f32 v224, v208, v209
    ds_read_b64_tr_b16 v[112:113], v4 offset:49152
    ds_read_b64_tr_b16 v[114:115], v4 offset:50176
    ds_read_b64_tr_b16 v[116:117], v5 offset:49152
    ds_read_b64_tr_b16 v[118:119], v5 offset:50176
    ds_read_b64_tr_b16 v[120:121], v6 offset:49152
    ds_read_b64_tr_b16 v[122:123], v6 offset:50176
    v_pk_mul_f32 v[222:223], v[206:207], v[206:207]
    v_exp_f32 v218, v218
    v_pk_fma_f32 v[222:223], v[222:223], v[234:235], v[234:235] op_sel:[0,0,1] op_sel_hi:[1,0,1]
    v_exp_f32 v219, v219
    v_pk_mul_f32 v[222:223], v[222:223], v[206:207]
    v_pk_fma_f32 v[216:217], v[216:217], v[238:239], v[238:239] op_sel:[0,1,1] op_sel_hi:[1,1,1]
    v_rcp_f32 v214, v214
    v_pk_mul_f32 v[212:213], v[212:213], v[196:197]
    v_rcp_f32 v215, v215
    v_cvt_pk_bf16_f32 v225, v210, v211
    ds_read_b64_tr_b16 v[124:125], v7 offset:49152
    ds_read_b64_tr_b16 v[126:127], v7 offset:50176
    ds_read_b64_tr_b16 v[32:33], v4 offset:57344
    ds_read_b64_tr_b16 v[34:35], v4 offset:58368
    ds_read_b64_tr_b16 v[36:37], v5 offset:57344
    ds_read_b64_tr_b16 v[38:39], v5 offset:58368
    v_exp_f32 v220, v220
    v_exp_f32 v221, v221
    v_pk_fma_f32 v[218:219], v[218:219], v[238:239], v[238:239] op_sel:[0,1,1] op_sel_hi:[1,1,1]
    v_rcp_f32 v216, v216
    v_pk_mul_f32 v[214:215], v[214:215], v[198:199]
    v_rcp_f32 v217, v217
    v_cvt_pk_bf16_f32 v226, v212, v213
    s_add_u32 s69, s68, 122880
    ds_read_b64_tr_b16 v[40:41], v6 offset:57344
    ds_read_b64_tr_b16 v[42:43], v6 offset:58368
    ds_read_b64_tr_b16 v[44:45], v7 offset:57344
    ds_read_b64_tr_b16 v[46:47], v7 offset:58368
    v_add_u32 v4, 0xffff0000, v4
    v_add_u32 v5, 0xffff0000, v5
    v_add_u32 v6, 0xffff0000, v6
    v_add_u32 v7, 0xffff0000, v7
    ds_read_b64_tr_b16 v[48:49], v4 offset:49152
    ds_read_b64_tr_b16 v[50:51], v4 offset:50176
    v_exp_f32 v222, v222
    v_exp_f32 v223, v223
    v_pk_fma_f32 v[220:221], v[220:221], v[238:239], v[238:239] op_sel:[0,1,1] op_sel_hi:[1,1,1]
    v_rcp_f32 v218, v218
    v_pk_mul_f32 v[216:217], v[216:217], v[200:201]
    v_rcp_f32 v219, v219
    v_cvt_pk_bf16_f32 v227, v214, v215
    buffer_store_dwordx4 v[224:227], v2, s[52:55], s69 offen sc1
    ds_read_b64_tr_b16 v[52:53], v5 offset:49152
    ds_read_b64_tr_b16 v[54:55], v5 offset:50176
    ds_read_b64_tr_b16 v[56:57], v6 offset:49152
    ds_read_b64_tr_b16 v[58:59], v6 offset:50176
    ds_read_b64_tr_b16 v[60:61], v7 offset:49152
    ds_read_b64_tr_b16 v[62:63], v7 offset:50176
    v_pk_fma_f32 v[222:223], v[222:223], v[238:239], v[238:239] op_sel:[0,1,1] op_sel_hi:[1,1,1]
    v_rcp_f32 v220, v220
    v_pk_mul_f32 v[218:219], v[218:219], v[202:203]
    v_rcp_f32 v221, v221
    v_cvt_pk_bf16_f32 v224, v216, v217
    ds_read_b64_tr_b16 v[16:17], v4 offset:57344
    ds_read_b64_tr_b16 v[18:19], v4 offset:58368
    ds_read_b64_tr_b16 v[20:21], v5 offset:57344
    ds_read_b64_tr_b16 v[22:23], v5 offset:58368
    ds_read_b64_tr_b16 v[24:25], v6 offset:57344
    ds_read_b64_tr_b16 v[26:27], v6 offset:58368
    v_rcp_f32 v222, v222
    v_pk_mul_f32 v[220:221], v[220:221], v[204:205]
    v_rcp_f32 v223, v223
    v_cvt_pk_bf16_f32 v225, v218, v219
    v_mov_b32 v144, s21
    v_mov_b32 v145, s21
    v_mov_b32 v146, s21
    v_mov_b32 v147, s21
    v_lshlrev_b32 v148, 4, v1
    s_waitcnt vmcnt(3)
    s_mov_b64 exec, 0xff
    buffer_store_dwordx4 v[144:147], v148, s[52:55], s3 offen sc1
    s_mov_b64 exec, -1
    s_nop 0
    s_add_u32 s3, s3, 98304
    ds_read_b64_tr_b16 v[28:29], v7 offset:57344
    ds_read_b64_tr_b16 v[30:31], v7 offset:58368
    v_pk_mul_f32 v[222:223], v[222:223], v[206:207]
    v_cvt_pk_bf16_f32 v226, v220, v221
    s_add_u32 s69, s68, 172032
    v_cvt_pk_bf16_f32 v227, v222, v223
    buffer_store_dwordx4 v[224:227], v2, s[52:55], s69 offen sc1
    s_waitcnt lgkmcnt(0)
    s_barrier
    s_cmp_lt_u32 s36, 20
    s_cbranch_scc1 L_G2
    s_waitcnt vmcnt(0)
    s_mov_b64 exec, 0xff
    buffer_store_dwordx4 v[144:147], v148, s[52:55], s3 offen sc1
    s_mov_b64 exec, -1
    s_add_u32 s3, s3, 98304
    s_branch L_FIN
L_G2:
    v_min_u32 v10, 11, v1
    v_lshlrev_b32 v10, 7, v10
    v_mov_b32 v176, s21
    v_mov_b32 v177, s21
    v_mov_b32 v178, s21
    v_mov_b32 v179, s21
    v_lshlrev_b32 v180, 4, v1
    s_add_u32 m0, s78, 98304
    s_mul_i32 s76, s14, 80
    buffer_load_dwordx4 v8, s[48:51], s76 offen lds
    v_permlane16_swap_b32 v12, v14
    v_permlane16_swap_b32 v13, v15
    v_permlane16_swap_b32 v240, v242
    v_permlane16_swap_b32 v241, v243
    v_permlane16_swap_b32 v244, v246
    v_permlane16_swap_b32 v245, v247
    buffer_load_dwordx4 v9, s[48:51], s76 offen offset:1024 lds
    v_permlane16_swap_b32 v248, v250
    v_permlane16_swap_b32 v249, v251
    v_permlane16_swap_b32 v252, v254
    v_permlane16_swap_b32 v253, v255
    v_lshlrev_b32_e64 v208, 16, v12
    v_and_b32 v209, 0xffff0000, v12
PADG2:
    s_cbranch_execz WR44
    s_add_u32 m0, s78, 106496
    s_mul_i32 s76, s15, 80
    buffer_load_dwordx4 v8, s[48:51], s76 offen lds
    v_lshlrev_b32 v210, 16, v13
    v_and_b32 v211, 0xffff0000, v13
    v_lshlrev_b32 v212, 16, v14
    v_and_b32 v213, 0xffff0000, v14
    v_lshlrev_b32 v214, 16, v15
    v_and_b32 v215, 0xffff0000, v15
    buffer_load_dwordx4 v9, s[48:51], s76 offen offset:1024 lds
    v_lshlrev_b32 v144, 16, v240
    v_and_b32 v145, 0xffff0000, v240
    v_add_f32 v144, v144, v208
    v_add_f32 v145, v145, v209
    v_lshlrev_b32 v146, 16, v241
    v_and_b32 v147, 0xffff0000, v241
    s_add_u32 m0, s78, 114688
    s_mul_i32 s76, s4, 80
    s_add_u32 s76, s76, 40960
    buffer_load_dwordx4 v8, s[48:51], s76 offen lds
    v_add_f32 v146, v146, v210
    v_add_f32 v147, v147, v211
    v_lshlrev_b32 v148, 16, v242
    v_and_b32 v149, 0xffff0000, v242
    v_add_f32 v148, v148, v212
    v_add_f32 v149, v149, v213
    buffer_load_dwordx4 v9, s[48:51], s76 offen offset:1024 lds
    v_lshlrev_b32 v150, 16, v243
    v_and_b32 v151, 0xffff0000, v243
    v_add_f32 v150, v150, v214
    v_add_f32 v151, v151, v215
    v_lshlrev_b32_e64 v152, 16, v244
    v_and_b32 v153, 0xffff0000, v244
    s_add_u32 m0, s78, 122880
    s_mul_i32 s76, s5, 80
    s_add_u32 s76, s76, 40960
    buffer_load_dwordx4 v8, s[48:51], s76 offen lds
    v_add_f32 v152, v152, v208
    v_add_f32 v153, v153, v209
    v_lshlrev_b32 v154, 16, v245
    v_and_b32 v155, 0xffff0000, v245
    v_add_f32 v154, v154, v210
    v_add_f32 v155, v155, v211
    buffer_load_dwordx4 v9, s[48:51], s76 offen offset:1024 lds
    v_lshlrev_b32 v156, 16, v246
    v_and_b32 v157, 0xffff0000, v246
    v_add_f32 v156, v156, v212
    v_add_f32 v157, v157, v213
    v_lshlrev_b32_e64 v158, 16, v247
    v_and_b32 v159, 0xffff0000, v247
    s_add_u32 m0, s78, 32768
    s_mul_i32 s76, s6, 80
    s_add_u32 s76, s76, 40960
    buffer_load_dwordx4 v8, s[48:51], s76 offen lds
    v_add_f32 v158, v158, v214
    v_add_f32 v159, v159, v215
    v_lshlrev_b32 v160, 16, v248
    v_and_b32 v161, 0xffff0000, v248
    v_add_f32 v160, v160, v208
    v_add_f32 v161, v161, v209
    buffer_load_dwordx4 v9, s[48:51], s76 offen offset:1024 lds
    v_lshlrev_b32 v162, 16, v249
    v_and_b32 v163, 0xffff0000, v249
    v_add_f32 v162, v162, v210
    v_add_f32 v163, v163, v211
    v_lshlrev_b32_e64 v164, 16, v250
    v_and_b32 v165, 0xffff0000, v250
    s_add_u32 m0, s78, 40960
    s_mul_i32 s76, s7, 80
    s_add_u32 s76, s76, 40960
    buffer_load_dwordx4 v8, s[48:51], s76 offen lds
    v_add_f32 v164, v164, v212
    v_add_f32 v165, v165, v213
    v_lshlrev_b32 v166, 16, v251
    v_and_b32 v167, 0xffff0000, v251
    v_add_f32 v166, v166, v214
    v_add_f32 v167, v167, v215
    buffer_load_dword v2, v10, s[52:55], s66 offen sc1
    v_lshlrev_b32 v168, 16, v252
    v_and_b32 v169, 0xffff0000, v252
    v_add_f32 v168, v168, v208
    v_add_f32 v169, v169, v209
    v_lshlrev_b32_e64 v170, 16, v253
    v_and_b32 v171, 0xffff0000, v253
    buffer_load_dwordx4 v9, s[48:51], s76 offen offset:1024 lds
    v_add_f32 v170, v170, v210
    v_add_f32 v171, v171, v211
    v_lshlrev_b32 v172, 16, v254
    v_and_b32 v173, 0xffff0000, v254
    v_add_f32 v172, v172, v212
    v_add_f32_e64 v173, v173, v213
    s_add_u32 m0, s78, 49152
    s_mul_i32 s76, s8, 80
    s_add_u32 s76, s76, 40960
    buffer_load_dwordx4 v8, s[48:51], s76 offen lds
    v_lshlrev_b32 v174, 16, v255
    v_and_b32 v175, 0xffff0000, v255
    v_add_f32 v174, v174, v214
    v_add_f32 v175, v175, v215
    s_waitcnt vmcnt(14)
    s_mov_b64 exec, 0xff
    buffer_store_dwordx4 v[176:179], v180, s[52:55], s3 offen sc1
    s_mov_b64 exec, -1
    buffer_load_dwordx4 v9, s[48:51], s76 offen offset:1024 lds
    s_add_u32 m0, s78, 57344
    s_mul_i32 s76, s9, 80
    s_add_u32 s76, s76, 40960
    buffer_load_dwordx4 v8, s[48:51], s76 offen lds
    buffer_load_dwordx4 v9, s[48:51], s76 offen offset:1024 lds
    s_waitcnt vmcnt(6)
    v_cmp_ne_u32 vcc, s21, v2
    s_nop 0
    s_cbranch_vccz OK45
    s_mov_b32 s79, 0
P46:
    buffer_load_dword v2, v10, s[52:55], s66 offen sc1
    s_add_u32 s79, s79, 1
    s_waitcnt vmcnt(0)
    v_cmp_ne_u32 vcc, s21, v2
    s_nop 0
    s_cbranch_vccz PE47
    s_sleep 4
    s_cmp_gt_u32 s79, 32768
    s_cbranch_scc0 P46
PE47:
OK45:
    s_nop 0
    v_lshl_add_u32 v12, v1, 4, s73
    v_add_u32 v13, 49152, v12
    v_add_u32 v14, 98304, v12
    v_add_u32 v15, 147456, v12
    buffer_load_dwordx4 v[208:211], v12, s[52:55], s4 offen sc1
    buffer_load_dwordx4 v[212:215], v13, s[52:55], s4 offen sc1
    buffer_load_dwordx4 v[216:219], v14, s[52:55], s4 offen sc1
    buffer_load_dwordx4 v[220:223], v15, s[52:55], s4 offen sc1
    buffer_load_dwordx4 v[224:227], v12, s[52:55], s5 offen sc1
    buffer_load_dwordx4 v[228:231], v13, s[52:55], s5 offen sc1
    buffer_load_dwordx4 v[232:235], v14, s[52:55], s5 offen sc1
    buffer_load_dwordx4 v[236:239], v15, s[52:55], s5 offen sc1
    buffer_load_dwordx4 v[240:243], v12, s[52:55], s6 offen sc1
    buffer_load_dwordx4 v[244:247], v13, s[52:55], s6 offen sc1
    buffer_load_dwordx4 v[248:251], v14, s[52:55], s6 offen sc1
    buffer_load_dwordx4 v[252:255], v15, s[52:55], s6 offen sc1
    s_lshl_b32 s76, s34, 13
    v_lshl_add_u32 v2, v1, 4, s76
    v_bfe_u32 v10, v1, 2, 3
    s_lshl_b32 s76, s61, 2
    v_xor_b32 v10, s76, v10
    v_lshlrev_b32 v10, 5, v10
    v_lshrrev_b32 v11, 2, v1
    v_lshl_add_u32 v10, v11, 8, v10
    v_and_b32 v11, 3, v1
    v_lshl_add_u32 v10, v11, 3, v10
    s_mul_i32 s16, s60, 8320
    s_add_u32 s16, s16, 131072
    v_lshrrev_b32_e64 v8, 2, v1
    v_mul_u32_u24 v3, 1280, v8
    v_lshl_add_u32 v3, v11, 4, v3
    v_mul_u32_u24 v9, 80, v8
    v_lshl_add_u32 v9, v11, 4, v9
    s_lshl_b32 s76, s34, 13
    s_add_u32 s76, s76, 32768
    v_add_u32 v9, s76, v9
    v_and_b32 v8, 15, v1
    v_mul_u32_u24 v8, 80, v8
    v_lshrrev_b32 v11, 4, v1
    v_lshl_add_u32 v8, v11, 3, v8
    v_add_u32 v8, s76, v8
    s_waitcnt vmcnt(11)
    v_mfma_f32_16x16x32_bf16 v[144:147], v[16:19], v[208:211], v[144:147]
    v_mfma_f32_16x16x32_bf16 v[148:151], v[20:23], v[208:211], v[148:151]
    v_mfma_f32_16x16x32_bf16 v[176:179], v[24:27], v[208:211], 0
    v_mfma_f32_16x16x32_bf16 v[180:183], v[28:31], v[208:211], 0
    s_waitcnt vmcnt(10)
    v_mfma_f32_16x16x32_bf16 v[152:155], v[16:19], v[212:215], v[152:155]
    v_mfma_f32_16x16x32_bf16 v[156:159], v[20:23], v[212:215], v[156:159]
    buffer_load_dwordx4 v[208:211], v12, s[52:55], s7 offen sc1
    v_mfma_f32_16x16x32_bf16 v[184:187], v[24:27], v[212:215], 0
    v_mfma_f32_16x16x32_bf16 v[188:191], v[28:31], v[212:215], 0
    s_waitcnt vmcnt(10)
    v_mfma_f32_16x16x32_bf16 v[160:163], v[16:19], v[216:219], v[160:163]
    v_mfma_f32_16x16x32_bf16 v[164:167], v[20:23], v[216:219], v[164:167]
    buffer_load_dwordx4 v[212:215], v13, s[52:55], s7 offen sc1
    v_mfma_f32_16x16x32_bf16 v[192:195], v[24:27], v[216:219], 0
    v_mfma_f32_16x16x32_bf16 v[196:199], v[28:31], v[216:219], 0
    s_waitcnt vmcnt(10)
    v_mfma_f32_16x16x32_bf16 v[168:171], v[16:19], v[220:223], v[168:171]
    v_mfma_f32_16x16x32_bf16 v[172:175], v[20:23], v[220:223], v[172:175]
    buffer_load_dwordx4 v[216:219], v14, s[52:55], s7 offen sc1
    v_mfma_f32_16x16x32_bf16 v[200:203], v[24:27], v[220:223], 0
    v_mfma_f32_16x16x32_bf16 v[204:207], v[28:31], v[220:223], 0
    s_waitcnt vmcnt(10)
    v_mfma_f32_16x16x32_bf16 v[144:147], v[32:35], v[224:227], v[144:147]
    ds_read_b64_tr_b16 v[16:17], v4 offset:0
    v_mfma_f32_16x16x32_bf16 v[148:151], v[36:39], v[224:227], v[148:151]
    buffer_load_dwordx4 v[220:223], v15, s[52:55], s7 offen sc1
    v_mfma_f32_16x16x32_bf16 v[176:179], v[40:43], v[224:227], v[176:179]
    ds_read_b64_tr_b16 v[18:19], v4 offset:1024
    v_mfma_f32_16x16x32_bf16 v[180:183], v[44:47], v[224:227], v[180:183]
    ds_read_b64_tr_b16 v[20:21], v5 offset:0
    s_waitcnt vmcnt(10)
    v_mfma_f32_16x16x32_bf16 v[152:155], v[32:35], v[228:231], v[152:155]
    ds_read_b64_tr_b16 v[22:23], v5 offset:1024
    v_mfma_f32_16x16x32_bf16 v[156:159], v[36:39], v[228:231], v[156:159]
    buffer_load_dwordx4 v[224:227], v12, s[52:55], s8 offen sc1
    v_mfma_f32_16x16x32_bf16 v[184:187], v[40:43], v[228:231], v[184:187]
    ds_read_b64_tr_b16 v[24:25], v6 offset:0
    v_mfma_f32_16x16x32_bf16 v[188:191], v[44:47], v[228:231], v[188:191]
    ds_read_b64_tr_b16 v[26:27], v6 offset:1024
    s_waitcnt vmcnt(10)
    v_mfma_f32_16x16x32_bf16 v[160:163], v[32:35], v[232:235], v[160:163]
    ds_read_b64_tr_b16 v[28:29], v7 offset:0
    v_mfma_f32_16x16x32_bf16 v[164:167], v[36:39], v[232:235], v[164:167]
    buffer_load_dwordx4 v[228:231], v13, s[52:55], s8 offen sc1
    v_mfma_f32_16x16x32_bf16 v[192:195], v[40:43], v[232:235], v[192:195]
    ds_read_b64_tr_b16 v[30:31], v7 offset:1024
    v_mfma_f32_16x16x32_bf16 v[196:199], v[44:47], v[232:235], v[196:199]
    s_waitcnt vmcnt(10)
    v_mfma_f32_16x16x32_bf16 v[168:171], v[32:35], v[236:239], v[168:171]
    v_mfma_f32_16x16x32_bf16 v[172:175], v[36:39], v[236:239], v[172:175]
    buffer_load_dwordx4 v[232:235], v14, s[52:55], s8 offen sc1
    v_mfma_f32_16x16x32_bf16 v[200:203], v[40:43], v[236:239], v[200:203]
    v_mfma_f32_16x16x32_bf16 v[204:207], v[44:47], v[236:239], v[204:207]
    s_waitcnt vmcnt(10) lgkmcnt(0)
    v_mfma_f32_16x16x32_bf16 v[144:147], v[16:19], v[240:243], v[144:147]
    ds_read_b64_tr_b16 v[32:33], v4 offset:8192
    v_mfma_f32_16x16x32_bf16 v[148:151], v[20:23], v[240:243], v[148:151]
    buffer_load_dwordx4 v[236:239], v15, s[52:55], s8 offen sc1
    v_mfma_f32_16x16x32_bf16 v[176:179], v[24:27], v[240:243], v[176:179]
    ds_read_b64_tr_b16 v[34:35], v4 offset:9216
    v_mfma_f32_16x16x32_bf16 v[180:183], v[28:31], v[240:243], v[180:183]
    ds_read_b64_tr_b16 v[36:37], v5 offset:8192
    s_waitcnt vmcnt(10)
    v_mfma_f32_16x16x32_bf16 v[152:155], v[16:19], v[244:247], v[152:155]
    ds_read_b64_tr_b16 v[38:39], v5 offset:9216
    v_mfma_f32_16x16x32_bf16 v[156:159], v[20:23], v[244:247], v[156:159]
    buffer_load_dwordx4 v[240:243], v12, s[52:55], s9 offen sc1
    v_mfma_f32_16x16x32_bf16 v[184:187], v[24:27], v[244:247], v[184:187]
    ds_read_b64_tr_b16 v[40:41], v6 offset:8192
    v_mfma_f32_16x16x32_bf16 v[188:191], v[28:31], v[244:247], v[188:191]
    ds_read_b64_tr_b16 v[42:43], v6 offset:9216
    s_waitcnt vmcnt(10)
    v_mfma_f32_16x16x32_bf16 v[160:163], v[16:19], v[248:251], v[160:163]
    ds_read_b64_tr_b16 v[44:45], v7 offset:8192
    v_mfma_f32_16x16x32_bf16 v[164:167], v[20:23], v[248:251], v[164:167]
    buffer_load_dwordx4 v[244:247], v13, s[52:55], s9 offen sc1
    v_mfma_f32_16x16x32_bf16 v[192:195], v[24:27], v[248:251], v[192:195]
    ds_read_b64_tr_b16 v[46:47], v7 offset:9216
    v_mfma_f32_16x16x32_bf16 v[196:199], v[28:31], v[248:251], v[196:199]
    s_waitcnt vmcnt(10)
    v_mfma_f32_16x16x32_bf16 v[168:171], v[16:19], v[252:255], v[168:171]
    v_mfma_f32_16x16x32_bf16 v[172:175], v[20:23], v[252:255], v[172:175]
    buffer_load_dwordx4 v[248:251], v14, s[52:55], s9 offen sc1
    v_mfma_f32_16x16x32_bf16 v[200:203], v[24:27], v[252:255], v[200:203]
    v_mfma_f32_16x16x32_bf16 v[204:207], v[28:31], v[252:255], v[204:207]
    s_waitcnt vmcnt(10) lgkmcnt(0)
    v_mfma_f32_16x16x32_bf16 v[144:147], v[32:35], v[208:211], v[144:147]
    ds_read_b64_tr_b16 v[16:17], v4 offset:16384
    v_mfma_f32_16x16x32_bf16 v[148:151], v[36:39], v[208:211], v[148:151]
    buffer_load_dwordx4 v[252:255], v15, s[52:55], s9 offen sc1
    v_mfma_f32_16x16x32_bf16 v[176:179], v[40:43], v[208:211], v[176:179]
    ds_read_b64_tr_b16 v[18:19], v4 offset:17408
    v_mfma_f32_16x16x32_bf16 v[180:183], v[44:47], v[208:211], v[180:183]
    ds_read_b64_tr_b16 v[20:21], v5 offset:16384
    s_waitcnt vmcnt(10)
    v_mfma_f32_16x16x32_bf16 v[152:155], v[32:35], v[212:215], v[152:155]
    ds_read_b64_tr_b16 v[22:23], v5 offset:17408
    v_mfma_f32_16x16x32_bf16 v[156:159], v[36:39], v[212:215], v[156:159]
    buffer_load_dwordx4 v[208:211], v12, s[52:55], s10 offen sc1
    v_mfma_f32_16x16x32_bf16 v[184:187], v[40:43], v[212:215], v[184:187]
    ds_read_b64_tr_b16 v[24:25], v6 offset:16384
    v_mfma_f32_16x16x32_bf16 v[188:191], v[44:47], v[212:215], v[188:191]
    ds_read_b64_tr_b16 v[26:27], v6 offset:17408
    s_waitcnt vmcnt(10)
    v_mfma_f32_16x16x32_bf16 v[160:163], v[32:35], v[216:219], v[160:163]
    ds_read_b64_tr_b16 v[28:29], v7 offset:16384
    v_mfma_f32_16x16x32_bf16 v[164:167], v[36:39], v[216:219], v[164:167]
    buffer_load_dwordx4 v[212:215], v13, s[52:55], s10 offen sc1
    v_mfma_f32_16x16x32_bf16 v[192:195], v[40:43], v[216:219], v[192:195]
    ds_read_b64_tr_b16 v[30:31], v7 offset:17408
    v_mfma_f32_16x16x32_bf16 v[196:199], v[44:47], v[216:219], v[196:199]
    s_waitcnt vmcnt(10)
    v_mfma_f32_16x16x32_bf16 v[168:171], v[32:35], v[220:223], v[168:171]
    v_mfma_f32_16x16x32_bf16 v[172:175], v[36:39], v[220:223], v[172:175]
    buffer_load_dwordx4 v[216:219], v14, s[52:55], s10 offen sc1
    v_mfma_f32_16x16x32_bf16 v[200:203], v[40:43], v[220:223], v[200:203]
    v_mfma_f32_16x16x32_bf16 v[204:207], v[44:47], v[220:223], v[204:207]
    s_waitcnt vmcnt(10) lgkmcnt(0)
    v_mfma_f32_16x16x32_bf16 v[144:147], v[16:19], v[224:227], v[144:147]
    ds_read_b64_tr_b16 v[32:33], v4 offset:24576
    v_mfma_f32_16x16x32_bf16 v[148:151], v[20:23], v[224:227], v[148:151]
    buffer_load_dwordx4 v[220:223], v15, s[52:55], s10 offen sc1
    v_mfma_f32_16x16x32_bf16 v[176:179], v[24:27], v[224:227], v[176:179]
    ds_read_b64_tr_b16 v[34:35], v4 offset:25600
    v_mfma_f32_16x16x32_bf16 v[180:183], v[28:31], v[224:227], v[180:183]
    ds_read_b64_tr_b16 v[36:37], v5 offset:24576
    s_waitcnt vmcnt(10)
    v_mfma_f32_16x16x32_bf16 v[152:155], v[16:19], v[228:231], v[152:155]
    ds_read_b64_tr_b16 v[38:39], v5 offset:25600
    v_mfma_f32_16x16x32_bf16 v[156:159], v[20:23], v[228:231], v[156:159]
    buffer_load_dwordx4 v[224:227], v12, s[52:55], s11 offen sc1
    v_mfma_f32_16x16x32_bf16 v[184:187], v[24:27], v[228:231], v[184:187]
    ds_read_b64_tr_b16 v[40:41], v6 offset:24576
    v_mfma_f32_16x16x32_bf16 v[188:191], v[28:31], v[228:231], v[188:191]
    ds_read_b64_tr_b16 v[42:43], v6 offset:25600
    s_waitcnt vmcnt(10)
    v_mfma_f32_16x16x32_bf16 v[160:163], v[16:19], v[232:235], v[160:163]
    ds_read_b64_tr_b16 v[44:45], v7 offset:24576
    v_mfma_f32_16x16x32_bf16 v[164:167], v[20:23], v[232:235], v[164:167]
    buffer_load_dwordx4 v[228:231], v13, s[52:55], s11 offen sc1
    v_mfma_f32_16x16x32_bf16 v[192:195], v[24:27], v[232:235], v[192:195]
    ds_read_b64_tr_b16 v[46:47], v7 offset:25600
    v_mfma_f32_16x16x32_bf16 v[196:199], v[28:31], v[232:235], v[196:199]
    s_waitcnt vmcnt(10)
    v_mfma_f32_16x16x32_bf16 v[168:171], v[16:19], v[236:239], v[168:171]
    v_mfma_f32_16x16x32_bf16 v[172:175], v[20:23], v[236:239], v[172:175]
    buffer_load_dwordx4 v[232:235], v14, s[52:55], s11 offen sc1
    v_mfma_f32_16x16x32_bf16 v[200:203], v[24:27], v[236:239], v[200:203]
    v_mfma_f32_16x16x32_bf16 v[204:207], v[28:31], v[236:239], v[204:207]
    v_add_u32 v4, 0x10000, v4
    v_add_u32 v5, 0x10000, v5
    v_add_u32 v6, 0x10000, v6
    v_add_u32 v7, 0x10000, v7
    s_waitcnt vmcnt(10) lgkmcnt(0)
    v_mfma_f32_16x16x32_bf16 v[144:147], v[32:35], v[240:243], v[144:147]
    ds_read_b64_tr_b16 v[16:17], v4 offset:0
    v_mfma_f32_16x16x32_bf16 v[148:151], v[36:39], v[240:243], v[148:151]
    buffer_load_dwordx4 v[236:239], v15, s[52:55], s11 offen sc1
    v_mfma_f32_16x16x32_bf16 v[176:179], v[40:43], v[240:243], v[176:179]
    ds_read_b64_tr_b16 v[18:19], v4 offset:1024
    v_mfma_f32_16x16x32_bf16 v[180:183], v[44:47], v[240:243], v[180:183]
    ds_read_b64_tr_b16 v[20:21], v5 offset:0
    s_waitcnt vmcnt(10)
    v_mfma_f32_16x16x32_bf16 v[152:155], v[32:35], v[244:247], v[152:155]
    ds_read_b64_tr_b16 v[22:23], v5 offset:1024
    v_mfma_f32_16x16x32_bf16 v[156:159], v[36:39], v[244:247], v[156:159]
    buffer_load_dwordx4 v[240:243], v12, s[52:55], s12 offen sc1
    v_mfma_f32_16x16x32_bf16 v[184:187], v[40:43], v[244:247], v[184:187]
    ds_read_b64_tr_b16 v[24:25], v6 offset:0
    v_mfma_f32_16x16x32_bf16 v[188:191], v[44:47], v[244:247], v[188:191]
    ds_read_b64_tr_b16 v[26:27], v6 offset:1024
    s_waitcnt vmcnt(10)
    v_mfma_f32_16x16x32_bf16 v[160:163], v[32:35], v[248:251], v[160:163]
    ds_read_b64_tr_b16 v[28:29], v7 offset:0
    v_mfma_f32_16x16x32_bf16 v[164:167], v[36:39], v[248:251], v[164:167]
    buffer_load_dwordx4 v[244:247], v13, s[52:55], s12 offen sc1
    v_mfma_f32_16x16x32_bf16 v[192:195], v[40:43], v[248:251], v[192:195]
    ds_read_b64_tr_b16 v[30:31], v7 offset:1024
    v_mfma_f32_16x16x32_bf16 v[196:199], v[44:47], v[248:251], v[196:199]
    s_waitcnt vmcnt(10)
    v_mfma_f32_16x16x32_bf16 v[168:171], v[32:35], v[252:255], v[168:171]
    v_mfma_f32_16x16x32_bf16 v[172:175], v[36:39], v[252:255], v[172:175]
    buffer_load_dwordx4 v[248:251], v14, s[52:55], s12 offen sc1
    v_mfma_f32_16x16x32_bf16 v[200:203], v[40:43], v[252:255], v[200:203]
    v_mfma_f32_16x16x32_bf16 v[204:207], v[44:47], v[252:255], v[204:207]
    s_waitcnt vmcnt(10) lgkmcnt(0)
    v_mfma_f32_16x16x32_bf16 v[144:147], v[16:19], v[208:211], v[144:147]
    ds_read_b64_tr_b16 v[32:33], v4 offset:8192
    v_mfma_f32_16x16x32_bf16 v[148:151], v[20:23], v[208:211], v[148:151]
    buffer_load_dwordx4 v[252:255], v15, s[52:55], s12 offen sc1
    v_mfma_f32_16x16x32_bf16 v[176:179], v[24:27], v[208:211], v[176:179]
    ds_read_b64_tr_b16 v[34:35], v4 offset:9216
    v_mfma_f32_16x16x32_bf16 v[180:183], v[28:31], v[208:211], v[180:183]
    ds_read_b64_tr_b16 v[36:37], v5 offset:8192
    s_waitcnt vmcnt(10)
    v_mfma_f32_16x16x32_bf16 v[152:155], v[16:19], v[212:215], v[152:155]
    ds_read_b64_tr_b16 v[38:39], v5 offset:9216
    v_mfma_f32_16x16x32_bf16 v[156:159], v[20:23], v[212:215], v[156:159]
    buffer_load_dwordx4 v[208:211], v12, s[52:55], s13 offen sc1
    v_mfma_f32_16x16x32_bf16 v[184:187], v[24:27], v[212:215], v[184:187]
    ds_read_b64_tr_b16 v[40:41], v6 offset:8192
    v_mfma_f32_16x16x32_bf16 v[188:191], v[28:31], v[212:215], v[188:191]
    ds_read_b64_tr_b16 v[42:43], v6 offset:9216
    s_waitcnt vmcnt(10)
    v_mfma_f32_16x16x32_bf16 v[160:163], v[16:19], v[216:219], v[160:163]
    ds_read_b64_tr_b16 v[44:45], v7 offset:8192
    v_mfma_f32_16x16x32_bf16 v[164:167], v[20:23], v[216:219], v[164:167]
    buffer_load_dwordx4 v[212:215], v13, s[52:55], s13 offen sc1
    v_mfma_f32_16x16x32_bf16 v[192:195], v[24:27], v[216:219], v[192:195]
    ds_read_b64_tr_b16 v[46:47], v7 offset:9216
    v_mfma_f32_16x16x32_bf16 v[196:199], v[28:31], v[216:219], v[196:199]
    s_waitcnt vmcnt(10)
    v_mfma_f32_16x16x32_bf16 v[168:171], v[16:19], v[220:223], v[168:171]
    v_mfma_f32_16x16x32_bf16 v[172:175], v[20:23], v[220:223], v[172:175]
    buffer_load_dwordx4 v[216:219], v14, s[52:55], s13 offen sc1
    v_mfma_f32_16x16x32_bf16 v[200:203], v[24:27], v[220:223], v[200:203]
    v_mfma_f32_16x16x32_bf16 v[204:207], v[28:31], v[220:223], v[204:207]
    s_waitcnt vmcnt(10) lgkmcnt(0)
    v_mfma_f32_16x16x32_bf16 v[144:147], v[32:35], v[224:227], v[144:147]
    ds_read_b64_tr_b16 v[16:17], v4 offset:16384
    v_mfma_f32_16x16x32_bf16 v[148:151], v[36:39], v[224:227], v[148:151]
    buffer_load_dwordx4 v[220:223], v15, s[52:55], s13 offen sc1
    v_mfma_f32_16x16x32_bf16 v[176:179], v[40:43], v[224:227], v[176:179]
    ds_read_b64_tr_b16 v[18:19], v4 offset:17408
    v_mfma_f32_16x16x32_bf16 v[180:183], v[44:47], v[224:227], v[180:183]
    ds_read_b64_tr_b16 v[20:21], v5 offset:16384
    s_waitcnt vmcnt(10)
    v_mfma_f32_16x16x32_bf16 v[152:155], v[32:35], v[228:231], v[152:155]
    ds_read_b64_tr_b16 v[22:23], v5 offset:17408
    v_mfma_f32_16x16x32_bf16 v[156:159], v[36:39], v[228:231], v[156:159]
    buffer_load_dwordx4 v[224:227], v12, s[52:55], s14 offen sc1
    v_mfma_f32_16x16x32_bf16 v[184:187], v[40:43], v[228:231], v[184:187]
    ds_read_b64_tr_b16 v[24:25], v6 offset:16384
    v_mfma_f32_16x16x32_bf16 v[188:191], v[44:47], v[228:231], v[188:191]
    ds_read_b64_tr_b16 v[26:27], v6 offset:17408
    s_waitcnt vmcnt(10)
    v_mfma_f32_16x16x32_bf16 v[160:163], v[32:35], v[232:235], v[160:163]
    ds_read_b64_tr_b16 v[28:29], v7 offset:16384
    v_mfma_f32_16x16x32_bf16 v[164:167], v[36:39], v[232:235], v[164:167]
    buffer_load_dwordx4 v[228:231], v13, s[52:55], s14 offen sc1
    v_mfma_f32_16x16x32_bf16 v[192:195], v[40:43], v[232:235], v[192:195]
    ds_read_b64_tr_b16 v[30:31], v7 offset:17408
    v_mfma_f32_16x16x32_bf16 v[196:199], v[44:47], v[232:235], v[196:199]
    s_waitcnt vmcnt(10)
    v_mfma_f32_16x16x32_bf16 v[168:171], v[32:35], v[236:239], v[168:171]
    v_mfma_f32_16x16x32_bf16 v[172:175], v[36:39], v[236:239], v[172:175]
    buffer_load_dwordx4 v[232:235], v14, s[52:55], s14 offen sc1
    v_mfma_f32_16x16x32_bf16 v[200:203], v[40:43], v[236:239], v[200:203]
    v_mfma_f32_16x16x32_bf16 v[204:207], v[44:47], v[236:239], v[204:207]
    s_waitcnt vmcnt(10) lgkmcnt(0)
    v_mfma_f32_16x16x32_bf16 v[144:147], v[16:19], v[240:243], v[144:147]
    ds_read_b64_tr_b16 v[32:33], v4 offset:24576
    v_mfma_f32_16x16x32_bf16 v[148:151], v[20:23], v[240:243], v[148:151]
    buffer_load_dwordx4 v[236:239], v15, s[52:55], s14 offen sc1
    v_mfma_f32_16x16x32_bf16 v[176:179], v[24:27], v[240:243], v[176:179]
    ds_read_b64_tr_b16 v[34:35], v4 offset:25600
    v_mfma_f32_16x16x32_bf16 v[180:183], v[28:31], v[240:243], v[180:183]
    ds_read_b64_tr_b16 v[36:37], v5 offset:24576
    s_waitcnt vmcnt(10)
    v_mfma_f32_16x16x32_bf16 v[152:155], v[16:19], v[244:247], v[152:155]
    ds_read_b64_tr_b16 v[38:39], v5 offset:25600
    v_mfma_f32_16x16x32_bf16 v[156:159], v[20:23], v[244:247], v[156:159]
    buffer_load_dwordx4 v[240:243], v12, s[52:55], s15 offen sc1
    v_mfma_f32_16x16x32_bf16 v[184:187], v[24:27], v[244:247], v[184:187]
    ds_read_b64_tr_b16 v[40:41], v6 offset:24576
    v_mfma_f32_16x16x32_bf16 v[188:191], v[28:31], v[244:247], v[188:191]
    ds_read_b64_tr_b16 v[42:43], v6 offset:25600
    s_waitcnt vmcnt(10)
    v_mfma_f32_16x16x32_bf16 v[160:163], v[16:19], v[248:251], v[160:163]
    ds_read_b64_tr_b16 v[44:45], v7 offset:24576
    v_mfma_f32_16x16x32_bf16 v[164:167], v[20:23], v[248:251], v[164:167]
    buffer_load_dwordx4 v[244:247], v13, s[52:55], s15 offen sc1
    v_mfma_f32_16x16x32_bf16 v[192:195], v[24:27], v[248:251], v[192:195]
    ds_read_b64_tr_b16 v[46:47], v7 offset:25600
    v_mfma_f32_16x16x32_bf16 v[196:199], v[28:31], v[248:251], v[196:199]
    s_waitcnt vmcnt(10)
    v_mfma_f32_16x16x32_bf16 v[168:171], v[16:19], v[252:255], v[168:171]
    v_mfma_f32_16x16x32_bf16 v[172:175], v[20:23], v[252:255], v[172:175]
    buffer_load_dwordx4 v[248:251], v14, s[52:55], s15 offen sc1
    v_mfma_f32_16x16x32_bf16 v[200:203], v[24:27], v[252:255], v[200:203]
    v_mfma_f32_16x16x32_bf16 v[204:207], v[28:31], v[252:255], v[204:207]
    s_barrier
    s_waitcnt vmcnt(10) lgkmcnt(0)
    v_mfma_f32_16x16x32_bf16 v[144:147], v[32:35], v[208:211], v[144:147]
    ds_read_b64_tr_b16 v[16:17], v4 offset:32768
    v_mfma_f32_16x16x32_bf16 v[148:151], v[36:39], v[208:211], v[148:151]
    buffer_load_dwordx4 v[252:255], v15, s[52:55], s15 offen sc1
    v_mfma_f32_16x16x32_bf16 v[176:179], v[40:43], v[208:211], v[176:179]
    ds_read_b64_tr_b16 v[18:19], v4 offset:33792
    v_mfma_f32_16x16x32_bf16 v[180:183], v[44:47], v[208:211], v[180:183]
    ds_read_b64_tr_b16 v[20:21], v5 offset:32768
    s_waitcnt vmcnt(10)
    v_mfma_f32_16x16x32_bf16 v[152:155], v[32:35], v[212:215], v[152:155]
    ds_read_b64_tr_b16 v[22:23], v5 offset:33792
    v_mfma_f32_16x16x32_bf16 v[156:159], v[36:39], v[212:215], v[156:159]
    v_add_u32 v12, 24576, v12
    buffer_load_dwordx4 v[208:211], v12, s[52:55], s4 offen sc1
    v_mfma_f32_16x16x32_bf16 v[184:187], v[40:43], v[212:215], v[184:187]
    ds_read_b64_tr_b16 v[24:25], v6 offset:32768
    v_mfma_f32_16x16x32_bf16 v[188:191], v[44:47], v[212:215], v[188:191]
    ds_read_b64_tr_b16 v[26:27], v6 offset:33792
    s_waitcnt vmcnt(10)
    v_mfma_f32_16x16x32_bf16 v[160:163], v[32:35], v[216:219], v[160:163]
    ds_read_b64_tr_b16 v[28:29], v7 offset:32768
    v_mfma_f32_16x16x32_bf16 v[164:167], v[36:39], v[216:219], v[164:167]
    v_add_u32 v13, 24576, v13
    buffer_load_dwordx4 v[212:215], v13, s[52:55], s4 offen sc1
    v_mfma_f32_16x16x32_bf16 v[192:195], v[40:43], v[216:219], v[192:195]
    ds_read_b64_tr_b16 v[30:31], v7 offset:33792
    v_mfma_f32_16x16x32_bf16 v[196:199], v[44:47], v[216:219], v[196:199]
    s_waitcnt vmcnt(10)
    v_mfma_f32_16x16x32_bf16 v[168:171], v[32:35], v[220:223], v[168:171]
    v_mfma_f32_16x16x32_bf16 v[172:175], v[36:39], v[220:223], v[172:175]
    v_add_u32 v14, 24576, v14
    buffer_load_dwordx4 v[216:219], v14, s[52:55], s4 offen sc1
    v_mfma_f32_16x16x32_bf16 v[200:203], v[40:43], v[220:223], v[200:203]
    v_mfma_f32_16x16x32_bf16 v[204:207], v[44:47], v[220:223], v[204:207]
    s_waitcnt vmcnt(10) lgkmcnt(0)
    v_mfma_f32_16x16x32_bf16 v[144:147], v[16:19], v[224:227], v[144:147]
    ds_read_b64_tr_b16 v[32:33], v4 offset:40960
    v_mfma_f32_16x16x32_bf16 v[148:151], v[20:23], v[224:227], v[148:151]
    v_add_u32 v15, 24576, v15
    buffer_load_dwordx4 v[220:223], v15, s[52:55], s4 offen sc1
    v_mfma_f32_16x16x32_bf16 v[176:179], v[24:27], v[224:227], v[176:179]
    ds_read_b64_tr_b16 v[34:35], v4 offset:41984
    v_mfma_f32_16x16x32_bf16 v[180:183], v[28:31], v[224:227], v[180:183]
    ds_read_b64_tr_b16 v[36:37], v5 offset:40960
    s_waitcnt vmcnt(10)
    v_mfma_f32_16x16x32_bf16 v[152:155], v[16:19], v[228:231], v[152:155]
    ds_read_b64_tr_b16 v[38:39], v5 offset:41984
    v_mfma_f32_16x16x32_bf16 v[156:159], v[20:23], v[228:231], v[156:159]
    buffer_load_dwordx4 v[224:227], v12, s[52:55], s5 offen sc1
    v_mfma_f32_16x16x32_bf16 v[184:187], v[24:27], v[228:231], v[184:187]
    ds_read_b64_tr_b16 v[40:41], v6 offset:40960
    v_mfma_f32_16x16x32_bf16 v[188:191], v[28:31], v[228:231], v[188:191]
    ds_read_b64_tr_b16 v[42:43], v6 offset:41984
    s_waitcnt vmcnt(10)
    v_mfma_f32_16x16x32_bf16 v[160:163], v[16:19], v[232:235], v[160:163]
    ds_read_b64_tr_b16 v[44:45], v7 offset:40960
    v_mfma_f32_16x16x32_bf16 v[164:167], v[20:23], v[232:235], v[164:167]
    buffer_load_dwordx4 v[228:231], v13, s[52:55], s5 offen sc1
    v_mfma_f32_16x16x32_bf16 v[192:195], v[24:27], v[232:235], v[192:195]
    ds_read_b64_tr_b16 v[46:47], v7 offset:41984
    v_mfma_f32_16x16x32_bf16 v[196:199], v[28:31], v[232:235], v[196:199]
    s_waitcnt vmcnt(10)
    v_mfma_f32_16x16x32_bf16 v[168:171], v[16:19], v[236:239], v[168:171]
    v_mfma_f32_16x16x32_bf16 v[172:175], v[20:23], v[236:239], v[172:175]
    buffer_load_dwordx4 v[232:235], v14, s[52:55], s5 offen sc1
    v_mfma_f32_16x16x32_bf16 v[200:203], v[24:27], v[236:239], v[200:203]
    v_mfma_f32_16x16x32_bf16 v[204:207], v[28:31], v[236:239], v[204:207]
    s_waitcnt vmcnt(10) lgkmcnt(0)
    v_mfma_f32_16x16x32_bf16 v[144:147], v[32:35], v[240:243], v[144:147]
    ds_read_b64_tr_b16 v[16:17], v4 offset:49152
    v_mfma_f32_16x16x32_bf16 v[148:151], v[36:39], v[240:243], v[148:151]
    buffer_load_dwordx4 v[236:239], v15, s[52:55], s5 offen sc1
    v_mfma_f32_16x16x32_bf16 v[176:179], v[40:43], v[240:243], v[176:179]
    ds_read_b64_tr_b16 v[18:19], v4 offset:50176
    v_mfma_f32_16x16x32_bf16 v[180:183], v[44:47], v[240:243], v[180:183]
    ds_read_b64_tr_b16 v[20:21], v5 offset:49152
    s_waitcnt vmcnt(10)
    v_mfma_f32_16x16x32_bf16 v[152:155], v[32:35], v[244:247], v[152:155]
    ds_read_b64_tr_b16 v[22:23], v5 offset:50176
    v_mfma_f32_16x16x32_bf16 v[156:159], v[36:39], v[244:247], v[156:159]
    buffer_load_dwordx4 v[240:243], v12, s[52:55], s6 offen sc1
    v_mfma_f32_16x16x32_bf16 v[184:187], v[40:43], v[244:247], v[184:187]
    ds_read_b64_tr_b16 v[24:25], v6 offset:49152
    v_mfma_f32_16x16x32_bf16 v[188:191], v[44:47], v[244:247], v[188:191]
    ds_read_b64_tr_b16 v[26:27], v6 offset:50176
    s_waitcnt vmcnt(10)
    v_mfma_f32_16x16x32_bf16 v[160:163], v[32:35], v[248:251], v[160:163]
    ds_read_b64_tr_b16 v[28:29], v7 offset:49152
    v_mfma_f32_16x16x32_bf16 v[164:167], v[36:39], v[248:251], v[164:167]
    buffer_load_dwordx4 v[244:247], v13, s[52:55], s6 offen sc1
    v_mfma_f32_16x16x32_bf16 v[192:195], v[40:43], v[248:251], v[192:195]
    ds_read_b64_tr_b16 v[30:31], v7 offset:50176
    v_mfma_f32_16x16x32_bf16 v[196:199], v[44:47], v[248:251], v[196:199]
    s_waitcnt vmcnt(10)
    v_mfma_f32_16x16x32_bf16 v[168:171], v[32:35], v[252:255], v[168:171]
    v_mfma_f32_16x16x32_bf16 v[172:175], v[36:39], v[252:255], v[172:175]
    buffer_load_dwordx4 v[248:251], v14, s[52:55], s6 offen sc1
    v_mfma_f32_16x16x32_bf16 v[200:203], v[40:43], v[252:255], v[200:203]
    v_mfma_f32_16x16x32_bf16 v[204:207], v[44:47], v[252:255], v[204:207]
    s_waitcnt vmcnt(10) lgkmcnt(0)
    v_mfma_f32_16x16x32_bf16 v[144:147], v[16:19], v[208:211], v[144:147]
    ds_read_b64_tr_b16 v[32:33], v4 offset:57344
    v_mfma_f32_16x16x32_bf16 v[148:151], v[20:23], v[208:211], v[148:151]
    buffer_load_dwordx4 v[252:255], v15, s[52:55], s6 offen sc1
    v_mfma_f32_16x16x32_bf16 v[176:179], v[24:27], v[208:211], v[176:179]
    ds_read_b64_tr_b16 v[34:35], v4 offset:58368
    v_mfma_f32_16x16x32_bf16 v[180:183], v[28:31], v[208:211], v[180:183]
    ds_read_b64_tr_b16 v[36:37], v5 offset:57344
    s_waitcnt vmcnt(10)
    v_mfma_f32_16x16x32_bf16 v[152:155], v[16:19], v[212:215], v[152:155]
    ds_read_b64_tr_b16 v[38:39], v5 offset:58368
    v_mfma_f32_16x16x32_bf16 v[156:159], v[20:23], v[212:215], v[156:159]
    buffer_load_dwordx4 v[208:211], v12, s[52:55], s7 offen sc1
    v_mfma_f32_16x16x32_bf16 v[184:187], v[24:27], v[212:215], v[184:187]
    ds_read_b64_tr_b16 v[40:41], v6 offset:57344
    v_mfma_f32_16x16x32_bf16 v[188:191], v[28:31], v[212:215], v[188:191]
    ds_read_b64_tr_b16 v[42:43], v6 offset:58368
    s_waitcnt vmcnt(10)
    v_mfma_f32_16x16x32_bf16 v[160:163], v[16:19], v[216:219], v[160:163]
    ds_read_b64_tr_b16 v[44:45], v7 offset:57344
    v_mfma_f32_16x16x32_bf16 v[164:167], v[20:23], v[216:219], v[164:167]
    buffer_load_dwordx4 v[212:215], v13, s[52:55], s7 offen sc1
    v_mfma_f32_16x16x32_bf16 v[192:195], v[24:27], v[216:219], v[192:195]
    ds_read_b64_tr_b16 v[46:47], v7 offset:58368
PADG3:
    s_cbranch_execz WR44
    v_mfma_f32_16x16x32_bf16 v[196:199], v[28:31], v[216:219], v[196:199]
    s_waitcnt vmcnt(10)
    v_mfma_f32_16x16x32_bf16 v[168:171], v[16:19], v[220:223], v[168:171]
    v_mfma_f32_16x16x32_bf16 v[172:175], v[20:23], v[220:223], v[172:175]
    buffer_load_dwordx4 v[216:219], v14, s[52:55], s7 offen sc1
    v_mfma_f32_16x16x32_bf16 v[200:203], v[24:27], v[220:223], v[200:203]
    v_mfma_f32_16x16x32_bf16 v[204:207], v[28:31], v[220:223], v[204:207]
    v_add_u32 v4, 0xffff0000, v4
    v_add_u32 v5, 0xffff0000, v5
    v_add_u32 v6, 0xffff0000, v6
    v_add_u32 v7, 0xffff0000, v7
    s_waitcnt vmcnt(10) lgkmcnt(0)
    v_mfma_f32_16x16x32_bf16 v[144:147], v[32:35], v[224:227], v[144:147]
    ds_read_b64_tr_b16 v[16:17], v4 offset:32768
    v_mfma_f32_16x16x32_bf16 v[148:151], v[36:39], v[224:227], v[148:151]
    buffer_load_dwordx4 v[220:223], v15, s[52:55], s7 offen sc1
    v_mfma_f32_16x16x32_bf16 v[176:179], v[40:43], v[224:227], v[176:179]
    ds_read_b64_tr_b16 v[18:19], v4 offset:33792
    v_mfma_f32_16x16x32_bf16 v[180:183], v[44:47], v[224:227], v[180:183]
    ds_read_b64_tr_b16 v[20:21], v5 offset:32768
    s_waitcnt vmcnt(10)
    v_mfma_f32_16x16x32_bf16 v[152:155], v[32:35], v[228:231], v[152:155]
    ds_read_b64_tr_b16 v[22:23], v5 offset:33792
    v_mfma_f32_16x16x32_bf16 v[156:159], v[36:39], v[228:231], v[156:159]
    buffer_load_dwordx4 v[224:227], v12, s[52:55], s8 offen sc1
    v_mfma_f32_16x16x32_bf16 v[184:187], v[40:43], v[228:231], v[184:187]
    ds_read_b64_tr_b16 v[24:25], v6 offset:32768
    v_mfma_f32_16x16x32_bf16 v[188:191], v[44:47], v[228:231], v[188:191]
    ds_read_b64_tr_b16 v[26:27], v6 offset:33792
    s_waitcnt vmcnt(10)
    v_mfma_f32_16x16x32_bf16 v[160:163], v[32:35], v[232:235], v[160:163]
    ds_read_b64_tr_b16 v[28:29], v7 offset:32768
    v_mfma_f32_16x16x32_bf16 v[164:167], v[36:39], v[232:235], v[164:167]
    buffer_load_dwordx4 v[228:231], v13, s[52:55], s8 offen sc1
    v_mfma_f32_16x16x32_bf16 v[192:195], v[40:43], v[232:235], v[192:195]
    ds_read_b64_tr_b16 v[30:31], v7 offset:33792
    v_mfma_f32_16x16x32_bf16 v[196:199], v[44:47], v[232:235], v[196:199]
    s_waitcnt vmcnt(10)
    v_mfma_f32_16x16x32_bf16 v[168:171], v[32:35], v[236:239], v[168:171]
    v_mfma_f32_16x16x32_bf16 v[172:175], v[36:39], v[236:239], v[172:175]
    buffer_load_dwordx4 v[232:235], v14, s[52:55], s8 offen sc1
    v_mfma_f32_16x16x32_bf16 v[200:203], v[40:43], v[236:239], v[200:203]
    v_mfma_f32_16x16x32_bf16 v[204:207], v[44:47], v[236:239], v[204:207]
    s_waitcnt vmcnt(10) lgkmcnt(0)
    v_mfma_f32_16x16x32_bf16 v[144:147], v[16:19], v[240:243], v[144:147]
    ds_read_b64_tr_b16 v[32:33], v4 offset:40960
    v_mfma_f32_16x16x32_bf16 v[148:151], v[20:23], v[240:243], v[148:151]
    buffer_load_dwordx4 v[236:239], v15, s[52:55], s8 offen sc1
    v_mfma_f32_16x16x32_bf16 v[176:179], v[24:27], v[240:243], v[176:179]
    ds_read_b64_tr_b16 v[34:35], v4 offset:41984
    v_mfma_f32_16x16x32_bf16 v[180:183], v[28:31], v[240:243], v[180:183]
    ds_read_b64_tr_b16 v[36:37], v5 offset:40960
    s_waitcnt vmcnt(10)
    v_mfma_f32_16x16x32_bf16 v[152:155], v[16:19], v[244:247], v[152:155]
    ds_read_b64_tr_b16 v[38:39], v5 offset:41984
    v_mfma_f32_16x16x32_bf16 v[156:159], v[20:23], v[244:247], v[156:159]
    buffer_load_dwordx4 v[240:243], v12, s[52:55], s9 offen sc1
    v_mfma_f32_16x16x32_bf16 v[184:187], v[24:27], v[244:247], v[184:187]
    ds_read_b64_tr_b16 v[40:41], v6 offset:40960
    v_mfma_f32_16x16x32_bf16 v[188:191], v[28:31], v[244:247], v[188:191]
    ds_read_b64_tr_b16 v[42:43], v6 offset:41984
    s_waitcnt vmcnt(10)
    v_mfma_f32_16x16x32_bf16 v[160:163], v[16:19], v[248:251], v[160:163]
    ds_read_b64_tr_b16 v[44:45], v7 offset:40960
    v_mfma_f32_16x16x32_bf16 v[164:167], v[20:23], v[248:251], v[164:167]
    buffer_load_dwordx4 v[244:247], v13, s[52:55], s9 offen sc1
    v_mfma_f32_16x16x32_bf16 v[192:195], v[24:27], v[248:251], v[192:195]
    ds_read_b64_tr_b16 v[46:47], v7 offset:41984
    v_mfma_f32_16x16x32_bf16 v[196:199], v[28:31], v[248:251], v[196:199]
    s_waitcnt vmcnt(10)
    v_mfma_f32_16x16x32_bf16 v[168:171], v[16:19], v[252:255], v[168:171]
    v_mfma_f32_16x16x32_bf16 v[172:175], v[20:23], v[252:255], v[172:175]
    buffer_load_dwordx4 v[248:251], v14, s[52:55], s9 offen sc1
    v_mfma_f32_16x16x32_bf16 v[200:203], v[24:27], v[252:255], v[200:203]
    v_mfma_f32_16x16x32_bf16 v[204:207], v[28:31], v[252:255], v[204:207]
    s_waitcnt vmcnt(10) lgkmcnt(0)
    v_mfma_f32_16x16x32_bf16 v[144:147], v[32:35], v[208:211], v[144:147]
    ds_read_b64_tr_b16 v[16:17], v4 offset:49152
    v_mfma_f32_16x16x32_bf16 v[148:151], v[36:39], v[208:211], v[148:151]
    buffer_load_dwordx4 v[252:255], v15, s[52:55], s9 offen sc1
    v_mfma_f32_16x16x32_bf16 v[176:179], v[40:43], v[208:211], v[176:179]
    ds_read_b64_tr_b16 v[18:19], v4 offset:50176
    v_mfma_f32_16x16x32_bf16 v[180:183], v[44:47], v[208:211], v[180:183]
    ds_read_b64_tr_b16 v[20:21], v5 offset:49152
    s_waitcnt vmcnt(10)
    v_mfma_f32_16x16x32_bf16 v[152:155], v[32:35], v[212:215], v[152:155]
    ds_read_b64_tr_b16 v[22:23], v5 offset:50176
    v_mfma_f32_16x16x32_bf16 v[156:159], v[36:39], v[212:215], v[156:159]
    buffer_load_dwordx4 v[208:211], v12, s[52:55], s10 offen sc1
    v_mfma_f32_16x16x32_bf16 v[184:187], v[40:43], v[212:215], v[184:187]
    ds_read_b64_tr_b16 v[24:25], v6 offset:49152
    v_mfma_f32_16x16x32_bf16 v[188:191], v[44:47], v[212:215], v[188:191]
    ds_read_b64_tr_b16 v[26:27], v6 offset:50176
    s_waitcnt vmcnt(10)
    v_mfma_f32_16x16x32_bf16 v[160:163], v[32:35], v[216:219], v[160:163]
    ds_read_b64_tr_b16 v[28:29], v7 offset:49152
    v_mfma_f32_16x16x32_bf16 v[164:167], v[36:39], v[216:219], v[164:167]
    buffer_load_dwordx4 v[212:215], v13, s[52:55], s10 offen sc1
    v_mfma_f32_16x16x32_bf16 v[192:195], v[40:43], v[216:219], v[192:195]
    ds_read_b64_tr_b16 v[30:31], v7 offset:50176
    v_mfma_f32_16x16x32_bf16 v[196:199], v[44:47], v[216:219], v[196:199]
    s_waitcnt vmcnt(10)
    v_mfma_f32_16x16x32_bf16 v[168:171], v[32:35], v[220:223], v[168:171]
    v_mfma_f32_16x16x32_bf16 v[172:175], v[36:39], v[220:223], v[172:175]
    buffer_load_dwordx4 v[216:219], v14, s[52:55], s10 offen sc1
    v_mfma_f32_16x16x32_bf16 v[200:203], v[40:43], v[220:223], v[200:203]
    v_mfma_f32_16x16x32_bf16 v[204:207], v[44:47], v[220:223], v[204:207]
    s_waitcnt vmcnt(10) lgkmcnt(0)
    v_mfma_f32_16x16x32_bf16 v[144:147], v[16:19], v[224:227], v[144:147]
    ds_read_b64_tr_b16 v[32:33], v4 offset:57344
    v_mfma_f32_16x16x32_bf16 v[148:151], v[20:23], v[224:227], v[148:151]
    buffer_load_dwordx4 v[220:223], v15, s[52:55], s10 offen sc1
    v_mfma_f32_16x16x32_bf16 v[176:179], v[24:27], v[224:227], v[176:179]
    ds_read_b64_tr_b16 v[34:35], v4 offset:58368
    v_mfma_f32_16x16x32_bf16 v[180:183], v[28:31], v[224:227], v[180:183]
    ds_read_b64_tr_b16 v[36:37], v5 offset:57344
    s_waitcnt vmcnt(10)
    v_mfma_f32_16x16x32_bf16 v[152:155], v[16:19], v[228:231], v[152:155]
    ds_read_b64_tr_b16 v[38:39], v5 offset:58368
    v_mfma_f32_16x16x32_bf16 v[156:159], v[20:23], v[228:231], v[156:159]
    buffer_load_dwordx4 v[224:227], v12, s[52:55], s11 offen sc1
    v_mfma_f32_16x16x32_bf16 v[184:187], v[24:27], v[228:231], v[184:187]
    ds_read_b64_tr_b16 v[40:41], v6 offset:57344
    v_mfma_f32_16x16x32_bf16 v[188:191], v[28:31], v[228:231], v[188:191]
    ds_read_b64_tr_b16 v[42:43], v6 offset:58368
    s_waitcnt vmcnt(10)
    v_mfma_f32_16x16x32_bf16 v[160:163], v[16:19], v[232:235], v[160:163]
    ds_read_b64_tr_b16 v[44:45], v7 offset:57344
    v_mfma_f32_16x16x32_bf16 v[164:167], v[20:23], v[232:235], v[164:167]
    buffer_load_dwordx4 v[228:231], v13, s[52:55], s11 offen sc1
    v_mfma_f32_16x16x32_bf16 v[192:195], v[24:27], v[232:235], v[192:195]
    ds_read_b64_tr_b16 v[46:47], v7 offset:58368
    v_mfma_f32_16x16x32_bf16 v[196:199], v[28:31], v[232:235], v[196:199]
    s_waitcnt vmcnt(10)
    v_mfma_f32_16x16x32_bf16 v[168:171], v[16:19], v[236:239], v[168:171]
    v_mfma_f32_16x16x32_bf16 v[172:175], v[20:23], v[236:239], v[172:175]
    buffer_load_dwordx4 v[232:235], v14, s[52:55], s11 offen sc1
    v_mfma_f32_16x16x32_bf16 v[200:203], v[24:27], v[236:239], v[200:203]
    v_mfma_f32_16x16x32_bf16 v[204:207], v[28:31], v[236:239], v[204:207]
    s_waitcnt vmcnt(10) lgkmcnt(0)
    v_mfma_f32_16x16x32_bf16 v[144:147], v[32:35], v[240:243], v[144:147]
    v_mfma_f32_16x16x32_bf16 v[148:151], v[36:39], v[240:243], v[148:151]
    buffer_load_dwordx4 v[236:239], v15, s[52:55], s11 offen sc1
    v_mfma_f32_16x16x32_bf16 v[176:179], v[40:43], v[240:243], v[176:179]
    v_mfma_f32_16x16x32_bf16 v[180:183], v[44:47], v[240:243], v[180:183]
    s_waitcnt vmcnt(10)
    v_mfma_f32_16x16x32_bf16 v[152:155], v[32:35], v[244:247], v[152:155]
    v_mfma_f32_16x16x32_bf16 v[156:159], v[36:39], v[244:247], v[156:159]
    buffer_load_dwordx4 v[240:243], v12, s[52:55], s12 offen sc1
    v_mfma_f32_16x16x32_bf16 v[184:187], v[40:43], v[244:247], v[184:187]
    v_mfma_f32_16x16x32_bf16 v[188:191], v[44:47], v[244:247], v[188:191]
    s_waitcnt vmcnt(10)
    v_mfma_f32_16x16x32_bf16 v[160:163], v[32:35], v[248:251], v[160:163]
    v_mfma_f32_16x16x32_bf16 v[164:167], v[36:39], v[248:251], v[164:167]
    buffer_load_dwordx4 v[244:247], v13, s[52:55], s12 offen sc1
    v_mfma_f32_16x16x32_bf16 v[192:195], v[40:43], v[248:251], v[192:195]
    v_mfma_f32_16x16x32_bf16 v[196:199], v[44:47], v[248:251], v[196:199]
    s_waitcnt vmcnt(10)
    v_mfma_f32_16x16x32_bf16 v[168:171], v[32:35], v[252:255], v[168:171]
    v_mfma_f32_16x16x32_bf16 v[172:175], v[36:39], v[252:255], v[172:175]
    buffer_load_dwordx4 v[248:251], v14, s[52:55], s12 offen sc1
    v_mfma_f32_16x16x32_bf16 v[200:203], v[40:43], v[252:255], v[200:203]
    v_mfma_f32_16x16x32_bf16 v[204:207], v[44:47], v[252:255], v[204:207]
    s_waitcnt vmcnt(10)
    v_mfma_f32_16x16x32_bf16 v[144:147], v[48:51], v[208:211], v[144:147]
    v_xor_b32 v4, 0, v10
    v_xor_b32 v5, 32, v10
    v_mfma_f32_16x16x32_bf16 v[148:151], v[52:55], v[208:211], v[148:151]
    buffer_load_dwordx4 v[252:255], v15, s[52:55], s12 offen sc1
    v_mfma_f32_16x16x32_bf16 v[176:179], v[56:59], v[208:211], v[176:179]
    v_xor_b32 v6, 64, v10
    v_xor_b32 v7, 96, v10
    v_mfma_f32_16x16x32_bf16 v[180:183], v[60:63], v[208:211], v[180:183]
    s_waitcnt vmcnt(10)
    v_mfma_f32_16x16x32_bf16 v[152:155], v[48:51], v[212:215], v[152:155]
    v_add_u32 v4, s16, v4
    v_add_u32 v5, s16, v5
    v_mfma_f32_16x16x32_bf16 v[156:159], v[52:55], v[212:215], v[156:159]
    buffer_load_dwordx4 v[208:211], v12, s[52:55], s13 offen sc1
    v_mfma_f32_16x16x32_bf16 v[184:187], v[56:59], v[212:215], v[184:187]
    v_add_u32 v6, s16, v6
    v_add_u32 v7, s16, v7
    v_mfma_f32_16x16x32_bf16 v[188:191], v[60:63], v[212:215], v[188:191]
    s_waitcnt vmcnt(10)
    v_mfma_f32_16x16x32_bf16 v[160:163], v[48:51], v[216:219], v[160:163]
    v_mfma_f32_16x16x32_bf16 v[164:167], v[52:55], v[216:219], v[164:167]
    buffer_load_dwordx4 v[212:215], v13, s[52:55], s13 offen sc1
    v_mfma_f32_16x16x32_bf16 v[192:195], v[56:59], v[216:219], v[192:195]
    v_mfma_f32_16x16x32_bf16 v[196:199], v[60:63], v[216:219], v[196:199]
    s_waitcnt vmcnt(10)
    v_mfma_f32_16x16x32_bf16 v[168:171], v[48:51], v[220:223], v[168:171]
    v_mfma_f32_16x16x32_bf16 v[172:175], v[52:55], v[220:223], v[172:175]
    buffer_load_dwordx4 v[216:219], v14, s[52:55], s13 offen sc1
    v_mfma_f32_16x16x32_bf16 v[200:203], v[56:59], v[220:223], v[200:203]
    v_mfma_f32_16x16x32_bf16 v[204:207], v[60:63], v[220:223], v[204:207]
    s_waitcnt vmcnt(10)
    v_mfma_f32_16x16x32_bf16 v[144:147], v[64:67], v[224:227], v[144:147]
    v_mfma_f32_16x16x32_bf16 v[148:151], v[68:71], v[224:227], v[148:151]
    buffer_load_dwordx4 v[220:223], v15, s[52:55], s13 offen sc1
    v_mfma_f32_16x16x32_bf16 v[176:179], v[72:75], v[224:227], v[176:179]
    v_mfma_f32_16x16x32_bf16 v[180:183], v[76:79], v[224:227], v[180:183]
    s_waitcnt vmcnt(10)
    v_mfma_f32_16x16x32_bf16 v[152:155], v[64:67], v[228:231], v[152:155]
    v_mfma_f32_16x16x32_bf16 v[156:159], v[68:71], v[228:231], v[156:159]
    buffer_load_dwordx4 v[224:227], v12, s[52:55], s14 offen sc1
    v_mfma_f32_16x16x32_bf16 v[184:187], v[72:75], v[228:231], v[184:187]
    v_mfma_f32_16x16x32_bf16 v[188:191], v[76:79], v[228:231], v[188:191]
    s_waitcnt vmcnt(10)
    v_mfma_f32_16x16x32_bf16 v[160:163], v[64:67], v[232:235], v[160:163]
    v_mfma_f32_16x16x32_bf16 v[164:167], v[68:71], v[232:235], v[164:167]
    buffer_load_dwordx4 v[228:231], v13, s[52:55], s14 offen sc1
    v_mfma_f32_16x16x32_bf16 v[192:195], v[72:75], v[232:235], v[192:195]
    v_mfma_f32_16x16x32_bf16 v[196:199], v[76:79], v[232:235], v[196:199]
    s_waitcnt vmcnt(10)
    v_mfma_f32_16x16x32_bf16 v[168:171], v[64:67], v[236:239], v[168:171]
    v_mfma_f32_16x16x32_bf16 v[172:175], v[68:71], v[236:239], v[172:175]
    buffer_load_dwordx4 v[232:235], v14, s[52:55], s14 offen sc1
    v_mfma_f32_16x16x32_bf16 v[200:203], v[72:75], v[236:239], v[200:203]
    v_mfma_f32_16x16x32_bf16 v[204:207], v[76:79], v[236:239], v[204:207]
    s_waitcnt vmcnt(10)
    v_mfma_f32_16x16x32_bf16 v[144:147], v[80:83], v[240:243], v[144:147]
    v_mfma_f32_16x16x32_bf16 v[148:151], v[84:87], v[240:243], v[148:151]
    buffer_load_dwordx4 v[236:239], v15, s[52:55], s14 offen sc1
    v_mfma_f32_16x16x32_bf16 v[176:179], v[88:91], v[240:243], v[176:179]
    v_mfma_f32_16x16x32_bf16 v[180:183], v[92:95], v[240:243], v[180:183]
    s_waitcnt vmcnt(10)
    v_mfma_f32_16x16x32_bf16 v[152:155], v[80:83], v[244:247], v[152:155]
    v_mfma_f32_16x16x32_bf16 v[156:159], v[84:87], v[244:247], v[156:159]
    buffer_load_dwordx4 v[240:243], v12, s[52:55], s15 offen sc1
    v_mfma_f32_16x16x32_bf16 v[184:187], v[88:91], v[244:247], v[184:187]
    v_mfma_f32_16x16x32_bf16 v[188:191], v[92:95], v[244:247], v[188:191]
    s_waitcnt vmcnt(10)
    v_mfma_f32_16x16x32_bf16 v[160:163], v[80:83], v[248:251], v[160:163]
    v_mfma_f32_16x16x32_bf16 v[164:167], v[84:87], v[248:251], v[164:167]
    buffer_load_dwordx4 v[244:247], v13, s[52:55], s15 offen sc1
    v_mfma_f32_16x16x32_bf16 v[192:195], v[88:91], v[248:251], v[192:195]
    v_mfma_f32_16x16x32_bf16 v[196:199], v[92:95], v[248:251], v[196:199]
    s_waitcnt vmcnt(10)
    v_mfma_f32_16x16x32_bf16 v[168:171], v[80:83], v[252:255], v[168:171]
    v_mfma_f32_16x16x32_bf16 v[172:175], v[84:87], v[252:255], v[172:175]
    buffer_load_dwordx4 v[248:251], v14, s[52:55], s15 offen sc1
    v_mfma_f32_16x16x32_bf16 v[200:203], v[88:91], v[252:255], v[200:203]
    v_mfma_f32_16x16x32_bf16 v[204:207], v[92:95], v[252:255], v[204:207]
    s_waitcnt vmcnt(10)
    v_mfma_f32_16x16x32_bf16 v[144:147], v[96:99], v[208:211], v[144:147]
    v_mfma_f32_16x16x32_bf16 v[148:151], v[100:103], v[208:211], v[148:151]
    buffer_load_dwordx4 v[252:255], v15, s[52:55], s15 offen sc1
    s_barrier
    v_mfma_f32_16x16x32_bf16 v[176:179], v[104:107], v[208:211], v[176:179]
    v_mfma_f32_16x16x32_bf16 v[180:183], v[108:111], v[208:211], v[180:183]
    s_waitcnt vmcnt(10)
    v_mfma_f32_16x16x32_bf16 v[152:155], v[96:99], v[212:215], v[152:155]
    v_mfma_f32_16x16x32_bf16 v[156:159], v[100:103], v[212:215], v[156:159]
    v_mfma_f32_16x16x32_bf16 v[184:187], v[104:107], v[212:215], v[184:187]
    v_mfma_f32_16x16x32_bf16 v[188:191], v[108:111], v[212:215], v[188:191]
    s_waitcnt vmcnt(9)
    v_mfma_f32_16x16x32_bf16 v[160:163], v[96:99], v[216:219], v[160:163]
    v_mfma_f32_16x16x32_bf16 v[164:167], v[100:103], v[216:219], v[164:167]
    v_mfma_f32_16x16x32_bf16 v[192:195], v[104:107], v[216:219], v[192:195]
    v_mfma_f32_16x16x32_bf16 v[196:199], v[108:111], v[216:219], v[196:199]
    s_waitcnt vmcnt(8)
    v_mfma_f32_16x16x32_bf16 v[168:171], v[96:99], v[220:223], v[168:171]
    v_mfma_f32_16x16x32_bf16 v[172:175], v[100:103], v[220:223], v[172:175]
    v_mfma_f32_16x16x32_bf16 v[200:203], v[104:107], v[220:223], v[200:203]
    v_mfma_f32_16x16x32_bf16 v[204:207], v[108:111], v[220:223], v[204:207]
    s_waitcnt vmcnt(7)
    v_mfma_f32_16x16x32_bf16 v[176:179], v[120:123], v[224:227], v[176:179]
    v_mfma_f32_16x16x32_bf16 v[180:183], v[124:127], v[224:227], v[180:183]
    s_waitcnt vmcnt(6)
    v_mfma_f32_16x16x32_bf16 v[184:187], v[120:123], v[228:231], v[184:187]
    v_mfma_f32_16x16x32_bf16 v[188:191], v[124:127], v[228:231], v[188:191]
    s_waitcnt vmcnt(5)
    v_mfma_f32_16x16x32_bf16 v[192:195], v[120:123], v[232:235], v[192:195]
    v_mfma_f32_16x16x32_bf16 v[196:199], v[124:127], v[232:235], v[196:199]
    s_waitcnt vmcnt(4)
    v_mfma_f32_16x16x32_bf16 v[200:203], v[120:123], v[236:239], v[200:203]
    v_mfma_f32_16x16x32_bf16 v[204:207], v[124:127], v[236:239], v[204:207]
    s_waitcnt vmcnt(3)
    v_mfma_f32_16x16x32_bf16 v[176:179], v[136:139], v[240:243], v[176:179]
    v_mfma_f32_16x16x32_bf16 v[180:183], v[140:143], v[240:243], v[180:183]
    s_waitcnt vmcnt(2)
    v_mfma_f32_16x16x32_bf16 v[184:187], v[136:139], v[244:247], v[184:187]
    v_mfma_f32_16x16x32_bf16 v[188:191], v[140:143], v[244:247], v[188:191]
    s_waitcnt vmcnt(1)
    v_mfma_f32_16x16x32_bf16 v[192:195], v[136:139], v[248:251], v[192:195]
    v_mfma_f32_16x16x32_bf16 v[196:199], v[140:143], v[248:251], v[196:199]
    s_waitcnt vmcnt(0)
    s_nop 0
    v_mfma_f32_16x16x32_bf16 v[200:203], v[136:139], v[252:255], v[200:203]
    v_mfma_f32_16x16x32_bf16 v[204:207], v[140:143], v[252:255], v[204:207]
    v_mfma_f32_16x16x32_bf16 v[144:147], v[112:115], v[224:227], v[144:147]
    ds_write_b128 v2, v[176:179] offset:0
    v_mfma_f32_16x16x32_bf16 v[148:151], v[116:119], v[224:227], v[148:151]
    v_mfma_f32_16x16x32_bf16 v[152:155], v[112:115], v[228:231], v[152:155]
    ds_write_b128 v2, v[180:183] offset:1024
    v_mfma_f32_16x16x32_bf16 v[156:159], v[116:119], v[228:231], v[156:159]
    v_mfma_f32_16x16x32_bf16 v[160:163], v[112:115], v[232:235], v[160:163]
    ds_write_b128 v2, v[184:187] offset:2048
    v_mfma_f32_16x16x32_bf16 v[164:167], v[116:119], v[232:235], v[164:167]
    v_mfma_f32_16x16x32_bf16 v[168:171], v[112:115], v[236:239], v[168:171]
    ds_write_b128 v2, v[188:191] offset:3072
    v_mfma_f32_16x16x32_bf16 v[172:175], v[116:119], v[236:239], v[172:175]
    v_mfma_f32_16x16x32_bf16 v[144:147], v[128:131], v[240:243], v[144:147]
    ds_write_b128 v2, v[192:195] offset:4096
    v_mfma_f32_16x16x32_bf16 v[148:151], v[132:135], v[240:243], v[148:151]
    v_mfma_f32_16x16x32_bf16 v[152:155], v[128:131], v[244:247], v[152:155]
    ds_write_b128 v2, v[196:199] offset:5120
    v_mfma_f32_16x16x32_bf16 v[156:159], v[132:135], v[244:247], v[156:159]
    v_mfma_f32_16x16x32_bf16 v[160:163], v[128:131], v[248:251], v[160:163]
    ds_write_b128 v2, v[200:203] offset:6144
    v_mfma_f32_16x16x32_bf16 v[164:167], v[132:135], v[248:251], v[164:167]
    v_mfma_f32_16x16x32_bf16 v[168:171], v[128:131], v[252:255], v[168:171]
    ds_write_b128 v2, v[204:207] offset:7168
    v_mfma_f32_16x16x32_bf16 v[172:175], v[132:135], v[252:255], v[172:175]
    v_xor_b32 v2, 0x2000, v2
    s_waitcnt lgkmcnt(0)
    s_barrier
    ds_read_b64_tr_b16 v[48:49], v4 offset:0
    ds_read_b128 v[176:179], v2 offset:0
    ds_read_b64_tr_b16 v[50:51], v4 offset:4160
    ds_read_b128 v[180:183], v2 offset:1024
    ds_read_b64_tr_b16 v[52:53], v5 offset:0
    ds_read_b128 v[184:187], v2 offset:2048
    ds_read_b64_tr_b16 v[54:55], v5 offset:4160
    ds_read_b128 v[188:191], v2 offset:3072
    ds_read_b64_tr_b16 v[56:57], v6 offset:0
    ds_read_b128 v[192:195], v2 offset:4096
    ds_read_b64_tr_b16 v[58:59], v6 offset:4160
    ds_read_b128 v[196:199], v2 offset:5120
    ds_read_b64_tr_b16 v[60:61], v7 offset:0
    ds_read_b128 v[200:203], v2 offset:6144
    ds_read_b64_tr_b16 v[62:63], v7 offset:4160
    ds_read_b128 v[204:207], v2 offset:7168
    s_waitcnt lgkmcnt(12)
    v_lshlrev_b32 v16, 16, v48
    v_and_b32 v17, 0xffff0000, v48
    v_lshlrev_b32 v18, 16, v49
    v_and_b32 v19, 0xffff0000, v49
    v_lshlrev_b32 v20, 16, v50
    v_and_b32 v21, 0xffff0000, v50
    v_lshlrev_b32_e64 v22, 16, v51
    v_and_b32 v23, 0xffff0000, v51
    v_pk_add_f32 v[144:145], v[144:145], v[176:177]
    v_pk_add_f32 v[146:147], v[146:147], v[178:179]
    v_pk_add_f32 v[148:149], v[148:149], v[180:181]
    v_pk_add_f32 v[150:151], v[150:151], v[182:183]
    v_pk_add_f32 v[144:145], v[144:145], v[16:17]
    v_pk_add_f32 v[146:147], v[146:147], v[18:19]
    v_pk_add_f32 v[148:149], v[148:149], v[20:21]
    v_pk_add_f32 v[150:151], v[150:151], v[22:23]
    v_cvt_pk_bf16_f32 v208, v144, v145
    v_cvt_pk_bf16_f32 v209, v146, v147
    v_cvt_pk_bf16_f32 v210, v148, v149
    v_cvt_pk_bf16_f32 v211, v150, v151
    ds_write_b64 v8, v[208:209] offset:0
    ds_write_b64 v8, v[210:211] offset:32
    ds_read_b128 v[224:227], v9 offset:0
    s_waitcnt lgkmcnt(11)
    v_lshlrev_b32 v16, 16, v52
    v_and_b32 v17, 0xffff0000, v52
    v_lshlrev_b32 v18, 16, v53
    v_and_b32 v19, 0xffff0000, v53
    v_lshlrev_b32 v20, 16, v54
    v_and_b32 v21, 0xffff0000, v54
    v_lshlrev_b32_e64 v22, 16, v55
    v_and_b32 v23, 0xffff0000, v55
    v_pk_add_f32 v[152:153], v[152:153], v[184:185]
    v_pk_add_f32 v[154:155], v[154:155], v[186:187]
    v_pk_add_f32 v[156:157], v[156:157], v[188:189]
    v_pk_add_f32 v[158:159], v[158:159], v[190:191]
    v_pk_add_f32 v[152:153], v[152:153], v[16:17]
    v_pk_add_f32 v[154:155], v[154:155], v[18:19]
    v_pk_add_f32 v[156:157], v[156:157], v[20:21]
    v_pk_add_f32 v[158:159], v[158:159], v[22:23]
    v_cvt_pk_bf16_f32 v212, v152, v153
    v_cvt_pk_bf16_f32 v213, v154, v155
    v_cvt_pk_bf16_f32 v214, v156, v157
    v_cvt_pk_bf16_f32 v215, v158, v159
    ds_write_b64 v8, v[212:213] offset:1280
    ds_write_b64 v8, v[214:215] offset:1312
    ds_read_b128 v[228:231], v9 offset:1280
    s_add_u32 s76, s72, 0
    s_waitcnt lgkmcnt(3)
    buffer_store_dwordx4 v[224:227], v3, s[56:59], s76 offen nt
    v_lshlrev_b32 v16, 16, v56
    v_and_b32 v17, 0xffff0000, v56
    v_lshlrev_b32 v18, 16, v57
    v_and_b32 v19, 0xffff0000, v57
    v_lshlrev_b32 v20, 16, v58
    v_and_b32 v21, 0xffff0000, v58
    v_lshlrev_b32 v22, 16, v59
    v_and_b32 v23, 0xffff0000, v59
    v_pk_add_f32 v[160:161], v[160:161], v[192:193]
    v_pk_add_f32 v[162:163], v[162:163], v[194:195]
    v_pk_add_f32 v[164:165], v[164:165], v[196:197]
    v_pk_add_f32 v[166:167], v[166:167], v[198:199]
    v_pk_add_f32 v[160:161], v[160:161], v[16:17]
    v_pk_add_f32 v[162:163], v[162:163], v[18:19]
    v_pk_add_f32 v[164:165], v[164:165], v[20:21]
    v_pk_add_f32 v[166:167], v[166:167], v[22:23]
    v_cvt_pk_bf16_f32 v216, v160, v161
    v_cvt_pk_bf16_f32 v217, v162, v163
    v_cvt_pk_bf16_f32 v218, v164, v165
    v_cvt_pk_bf16_f32 v219, v166, v167
    ds_write_b64 v8, v[216:217] offset:2560
    ds_write_b64 v8, v[218:219] offset:2592
    ds_read_b128 v[232:235], v9 offset:2560
    s_add_u32 s76, s72, 20480
    s_waitcnt lgkmcnt(3)
    buffer_store_dwordx4 v[228:231], v3, s[56:59], s76 offen nt
    v_lshlrev_b32 v16, 16, v60
    v_and_b32 v17, 0xffff0000, v60
    v_lshlrev_b32 v18, 16, v61
    v_and_b32 v19, 0xffff0000, v61
    v_lshlrev_b32 v20, 16, v62
    v_and_b32 v21, 0xffff0000, v62
    v_lshlrev_b32_e64 v22, 16, v63
    v_and_b32 v23, 0xffff0000, v63
    v_pk_add_f32 v[168:169], v[168:169], v[200:201]
    v_pk_add_f32 v[170:171], v[170:171], v[202:203]
    v_pk_add_f32 v[172:173], v[172:173], v[204:205]
    v_pk_add_f32 v[174:175], v[174:175], v[206:207]
    v_pk_add_f32 v[168:169], v[168:169], v[16:17]
    v_pk_add_f32 v[170:171], v[170:171], v[18:19]
    v_pk_add_f32 v[172:173], v[172:173], v[20:21]
    v_pk_add_f32 v[174:175], v[174:175], v[22:23]
    v_cvt_pk_bf16_f32 v220, v168, v169
    v_cvt_pk_bf16_f32 v221, v170, v171
    v_cvt_pk_bf16_f32 v222, v172, v173
    v_cvt_pk_bf16_f32 v223, v174, v175
    ds_write_b64 v8, v[220:221] offset:3840
    ds_write_b64 v8, v[222:223] offset:3872
    ds_read_b128 v[236:239], v9 offset:3840
    s_add_u32 s76, s72, 40960
    s_waitcnt lgkmcnt(3)
    buffer_store_dwordx4 v[232:235], v3, s[56:59], s76 offen nt
    s_add_u32 s76, s72, 61440
    s_waitcnt lgkmcnt(0)
    buffer_store_dwordx4 v[236:239], v3, s[56:59], s76 offen nt
    s_branch L_FIN
L_FIN:
L_END:
    s_endpgm
.section .rodata,"a"
.p2align 6
.amdhsa_kernel parallel_sum__ssm_conv_s4d__mixer_channel_mlp__prompt_kernel
  .amdhsa_next_free_vgpr 256
  .amdhsa_next_free_sgpr 102
  .amdhsa_accum_offset 256
  .amdhsa_group_segment_fixed_size 0
  .amdhsa_kernarg_size 120
  .amdhsa_user_sgpr_count 2
  .amdhsa_user_sgpr_kernarg_segment_ptr 1
  .amdhsa_system_sgpr_workgroup_id_x 1
  .amdhsa_float_denorm_mode_32 3
.end_amdhsa_kernel
```
